```python
import torch

def _softmax(x, axis=-1):
    return torch.softmax(x, dim=axis)
def _gelu(x):
    return torch.nn.functional.gelu(x, approximate="tanh")
def _silu(x):
    return torch.nn.functional.silu(x)
def _sigmoid(x):
    return torch.sigmoid(x)
def _layernorm(x, axis=-1, eps=1e-5):
    m = x.mean(dim=axis, keepdim=True)
    v = x.var(dim=axis, keepdim=True, unbiased=False)
    return (x - m) / torch.sqrt(v + eps)
def _scatter_add(tgt, idx, src, axis=0):
    return tgt.clone().index_add_(axis, idx, src)
def _segment_sum(src, seg, n):
    out = torch.zeros((n,) + src.shape[1:], dtype=src.dtype)
    return out.index_add_(0, seg, src)
def _pad(x, pw):
    flat = tuple(v for pair in reversed(pw) for v in pair)
    return torch.nn.functional.pad(x, flat)

kernel_name = 'standalone__edge_featured_mpnn_egc__graph'

def setup_inputs():

    _w = (lambda a: (lambda t: t.to(torch.bfloat16) if t.is_floating_point() else t)(torch.as_tensor(a)))
    N, deg, D, De = 12500, 32, 128, max(16, 1)
    E = N * deg
    return {
        "x": _w((lambda *s: torch.randn(*s, dtype=torch.bfloat16) * 0.1)(N, D)),
        "e_attr": _w((lambda *s: torch.randn(*s, dtype=torch.bfloat16) * 0.1)(E, De)),
        "src": _w((lambda lo, hi, *s: torch.randint(lo, hi, s))(0, N, E).to(torch.int64)),
        "dst": _w((lambda lo, hi, *s: torch.randint(lo, hi, s))(0, N, E).to(torch.int64)),
        "u_w": _w((lambda *s: torch.randn(*s, dtype=torch.bfloat16) * 0.05)(D, D)),
        "v_w": _w((lambda *s: torch.randn(*s, dtype=torch.bfloat16) * 0.05)(D, D)),
        "g_w": _w((lambda *s: torch.randn(*s, dtype=torch.bfloat16) * 0.1)(2 * D + De, D)),
    }

def reference(x, e_attr, src, dst, u_w, v_w, g_w):
    N, D = x.shape
    g_in = torch.concatenate([x[dst], x[src], e_attr], axis=-1)
    eta = _sigmoid(g_in @ g_w)
    hv = x @ v_w
    msg = eta * hv[src]
    agg = _segment_sum(msg, dst, N)
    return _silu(x @ u_w + agg)
```

```asm
; @launch kernel=egc_prep_kernel grid=(676,1,1) block=(256,1,1) lds=32784
; @launch kernel=standalone__edge_featured_mpnn_egc__graph_kernel grid=(1000,1,1) block=(256,1,1) lds=33568
.amdgcn_target "amdgcn-amd-amdhsa--gfx950"
.text
.globl egc_prep_kernel
.p2align 8
.type egc_prep_kernel,@function
egc_prep_kernel:
    s_cmp_ge_u32 s2, 676
    s_cbranch_scc1 K1_END
    s_load_dwordx4 s[4:7], s[0:1], 0
    s_load_dwordx4 s[8:11], s[0:1], 16
    s_load_dwordx4 s[12:15], s[0:1], 32
    s_load_dwordx2 s[16:17], s[0:1], 48
    s_load_dwordx2 s[18:19], s[0:1], 72
    v_lshrrev_b32 v1, 6, v0
    v_and_b32 v2, 63, v0
    v_readfirstlane_b32 s3, v1
    v_lshrrev_b32 v3, 4, v2
    v_and_b32 v4, 15, v2
    s_waitcnt lgkmcnt(0)
    s_cmp_ge_u32 s2, 256
    s_nop 0
    s_cbranch_scc1 K1_GEMM
    s_mov_b32 s20, s8
    s_mov_b32 s21, s9
    s_mov_b32 s22, 0x186a00
    s_mov_b32 s23, 0x00020000
    s_mov_b32 s24, s10
    s_mov_b32 s25, s11
    s_mov_b32 s26, 0x186a00
    s_mov_b32 s27, 0x00020000
    s_add_u32 s28, s18, 0xa00000
    s_addc_u32 s29, s19, 0
    s_mov_b32 s30, 0x808000
    s_mov_b32 s31, 0x00020000
    s_add_u32 s32, s18, 0x6a0000
    s_addc_u32 s33, s19, 0
    s_mov_b32 s34, 0x310000
    s_mov_b32 s35, 0x00020000
    s_mul_i32 s36, s2, 1563
    s_sub_u32 s37, 400000, s36
    s_min_u32 s37, s37, 1563
    v_add_u32 v6, s36, v0
    v_lshlrev_b32 v6, 2, v6
    s_mov_b32 s43, 4096
    buffer_load_dword v16, v6, s[24:27], 0 offen offset:0
    buffer_load_dword v24, v6, s[20:23], 0 offen offset:0
    buffer_load_dword v17, v6, s[24:27], 0 offen offset:1024
    buffer_load_dword v25, v6, s[20:23], 0 offen offset:1024
    buffer_load_dword v18, v6, s[24:27], 0 offen offset:2048
    buffer_load_dword v26, v6, s[20:23], 0 offen offset:2048
    buffer_load_dword v19, v6, s[24:27], 0 offen offset:3072
    buffer_load_dword v27, v6, s[20:23], 0 offen offset:3072
    buffer_load_dword v20, v6, s[24:27], s43 offen offset:0
    buffer_load_dword v28, v6, s[20:23], s43 offen offset:0
    buffer_load_dword v21, v6, s[24:27], s43 offen offset:1024
    buffer_load_dword v29, v6, s[20:23], s43 offen offset:1024
    buffer_load_dword v22, v6, s[24:27], s43 offen offset:2048
    buffer_load_dword v30, v6, s[20:23], s43 offen offset:2048
    v_mov_b32 v8, 0
    v_lshlrev_b32 v5, 5, v0
    ds_write_b32 v5, v8 offset:0
    ds_write_b32 v5, v8 offset:8192
    ds_write_b32 v5, v8 offset:16384
    ds_write_b32 v5, v8 offset:24576
    v_mov_b32 v9, 0x8000
    ds_write_b32 v9, v8
    v_mov_b32 v7, 1
    s_waitcnt lgkmcnt(0)
    s_barrier
    s_waitcnt vmcnt(12)
    v_mul_u32_u24 v12, 83888, v16
    v_lshrrev_b32 v12, 20, v12
    v_mad_u32_u24 v13, v12, 25, 1
    v_lshrrev_b32 v13, 1, v13
    v_sub_u32 v13, v16, v13
    v_add_u32 v14, 0, v0
    v_lshl_or_b32 v40, v13, 14, v24
    v_lshl_or_b32 v40, v14, 18, v40
    v_lshlrev_b32 v32, 5, v12
    ds_add_rtn_u32 v48, v32, v7
    s_waitcnt vmcnt(10)
    v_mul_u32_u24 v12, 83888, v17
    v_lshrrev_b32 v12, 20, v12
    v_mad_u32_u24 v13, v12, 25, 1
    v_lshrrev_b32 v13, 1, v13
    v_sub_u32 v13, v17, v13
    v_add_u32 v14, 256, v0
    v_lshl_or_b32 v41, v13, 14, v25
    v_lshl_or_b32 v41, v14, 18, v41
    v_lshlrev_b32 v33, 5, v12
    ds_add_rtn_u32 v49, v33, v7
    s_waitcnt vmcnt(8)
    v_mul_u32_u24 v12, 83888, v18
    v_lshrrev_b32 v12, 20, v12
    v_mad_u32_u24 v13, v12, 25, 1
    v_lshrrev_b32 v13, 1, v13
    v_sub_u32 v13, v18, v13
    v_add_u32 v14, 512, v0
    v_lshl_or_b32 v42, v13, 14, v26
    v_lshl_or_b32 v42, v14, 18, v42
    v_lshlrev_b32 v34, 5, v12
    ds_add_rtn_u32 v50, v34, v7
    s_waitcnt vmcnt(6)
    v_mul_u32_u24 v12, 83888, v19
    v_lshrrev_b32 v12, 20, v12
    v_mad_u32_u24 v13, v12, 25, 1
    v_lshrrev_b32 v13, 1, v13
    v_sub_u32 v13, v19, v13
    v_add_u32 v14, 768, v0
    v_lshl_or_b32 v43, v13, 14, v27
    v_lshl_or_b32 v43, v14, 18, v43
    v_lshlrev_b32 v35, 5, v12
    ds_add_rtn_u32 v51, v35, v7
    s_waitcnt vmcnt(4)
    v_mul_u32_u24 v12, 83888, v20
    v_lshrrev_b32 v12, 20, v12
    v_mad_u32_u24 v13, v12, 25, 1
    v_lshrrev_b32 v13, 1, v13
    v_sub_u32 v13, v20, v13
    v_add_u32 v14, 1024, v0
    v_lshl_or_b32 v44, v13, 14, v28
    v_lshl_or_b32 v44, v14, 18, v44
    v_lshlrev_b32 v36, 5, v12
    ds_add_rtn_u32 v52, v36, v7
    s_waitcnt vmcnt(2)
    v_mul_u32_u24 v12, 83888, v21
    v_lshrrev_b32 v12, 20, v12
    v_mad_u32_u24 v13, v12, 25, 1
    v_lshrrev_b32 v13, 1, v13
    v_sub_u32 v13, v21, v13
    v_add_u32 v14, 1280, v0
    v_lshl_or_b32 v45, v13, 14, v29
    v_lshl_or_b32 v45, v14, 18, v45
    v_cmp_gt_u32 vcc, s37, v14
    v_mov_b32 v15, 1023
    s_nop 0
    v_cndmask_b32 v12, v15, v12, vcc
    v_lshlrev_b32 v37, 5, v12
    ds_add_rtn_u32 v53, v37, v7
    s_waitcnt vmcnt(0)
    v_mul_u32_u24 v12, 83888, v22
    v_lshrrev_b32 v12, 20, v12
    v_mad_u32_u24 v13, v12, 25, 1
    v_lshrrev_b32 v13, 1, v13
    v_sub_u32 v13, v22, v13
    v_add_u32 v14, 1536, v0
    v_lshl_or_b32 v46, v13, 14, v30
    v_lshl_or_b32 v46, v14, 18, v46
    v_cmp_gt_u32 vcc, s37, v14
    v_mov_b32 v15, 1023
    s_nop 0
    v_cndmask_b32 v12, v15, v12, vcc
    v_lshlrev_b32 v38, 5, v12
    ds_add_rtn_u32 v54, v38, v7
    s_mov_b64 s[44:45], 0
    s_mov_b32 s42, 32736
    v_mov_b32 v15, 32736
    s_waitcnt lgkmcnt(6)
    v_lshl_add_u32 v12, v48, 2, v32
    v_cmp_gt_u32 vcc, 7, v48
    s_nop 1
    v_cndmask_b32 v12, v15, v12, vcc
    ds_write_b32 v12, v40 offset:4
    v_cmp_gt_u32 s[46:47], s42, v32
    s_andn2_b64 s[46:47], s[46:47], vcc
    s_or_b64 s[44:45], s[44:45], s[46:47]
    s_waitcnt lgkmcnt(5)
    v_lshl_add_u32 v12, v49, 2, v33
    v_cmp_gt_u32 vcc, 7, v49
    s_nop 1
    v_cndmask_b32 v12, v15, v12, vcc
    ds_write_b32 v12, v41 offset:4
    v_cmp_gt_u32 s[46:47], s42, v33
    s_andn2_b64 s[46:47], s[46:47], vcc
    s_or_b64 s[44:45], s[44:45], s[46:47]
    s_waitcnt lgkmcnt(4)
    v_lshl_add_u32 v12, v50, 2, v34
    v_cmp_gt_u32 vcc, 7, v50
    s_nop 1
    v_cndmask_b32 v12, v15, v12, vcc
    ds_write_b32 v12, v42 offset:4
    v_cmp_gt_u32 s[46:47], s42, v34
    s_andn2_b64 s[46:47], s[46:47], vcc
    s_or_b64 s[44:45], s[44:45], s[46:47]
    s_waitcnt lgkmcnt(3)
    v_lshl_add_u32 v12, v51, 2, v35
    v_cmp_gt_u32 vcc, 7, v51
    s_nop 1
    v_cndmask_b32 v12, v15, v12, vcc
    ds_write_b32 v12, v43 offset:4
    v_cmp_gt_u32 s[46:47], s42, v35
    s_andn2_b64 s[46:47], s[46:47], vcc
    s_or_b64 s[44:45], s[44:45], s[46:47]
    s_waitcnt lgkmcnt(2)
    v_lshl_add_u32 v12, v52, 2, v36
    v_cmp_gt_u32 vcc, 7, v52
    s_nop 1
    v_cndmask_b32 v12, v15, v12, vcc
    ds_write_b32 v12, v44 offset:4
    v_cmp_gt_u32 s[46:47], s42, v36
    s_andn2_b64 s[46:47], s[46:47], vcc
    s_or_b64 s[44:45], s[44:45], s[46:47]
    s_waitcnt lgkmcnt(1)
    v_lshl_add_u32 v12, v53, 2, v37
    v_cmp_gt_u32 vcc, 7, v53
    s_nop 1
    v_cndmask_b32 v12, v15, v12, vcc
    ds_write_b32 v12, v45 offset:4
    v_cmp_gt_u32 s[46:47], s42, v37
    s_andn2_b64 s[46:47], s[46:47], vcc
    s_or_b64 s[44:45], s[44:45], s[46:47]
    s_waitcnt lgkmcnt(0)
    v_lshl_add_u32 v12, v54, 2, v38
    v_cmp_gt_u32 vcc, 7, v54
    s_nop 1
    v_cndmask_b32 v12, v15, v12, vcc
    ds_write_b32 v12, v46 offset:4
    v_cmp_gt_u32 s[46:47], s42, v38
    s_andn2_b64 s[46:47], s[46:47], vcc
    s_or_b64 s[44:45], s[44:45], s[46:47]
    s_cmp_eq_u64 s[44:45], 0
    s_nop 1
    s_cbranch_scc1 K1_NOOVF
    s_add_u32 s48, s18, 0x1280000
    s_addc_u32 s49, s19, 0
    s_mov_b32 s50, 0x808000
    s_mov_b32 s51, 0x00020000
    s_mul_i32 s38, s2, 12544
    s_mul_i32 s39, s2, 32896
    v_cmp_gt_u32 s[46:47], s42, v32
    v_cmp_lt_u32 vcc, 6, v48
    s_and_b64 vcc, vcc, s[46:47]
    s_and_saveexec_b64 s[46:47], vcc
    s_nop 2
    s_cbranch_execz K1_OV0
    v_lshl_add_u32 v12, v48, 2, v32
    v_subrev_u32 v12, 28, v12
    v_mov_b32 v13, 0x80000000
    v_cmp_gt_u32 vcc, 15, v48
    s_nop 1
    v_cndmask_b32 v12, v13, v12, vcc
    buffer_store_dword v40, v12, s[48:51], s39 offen
    s_andn2_b64 exec, exec, vcc
    s_cbranch_execz K1_OV0
    ds_add_rtn_u32 v12, v9, v7
    v_lshrrev_b32 v14, 5, v32
    v_mov_b32 v15, v40
    s_waitcnt lgkmcnt(0)
    v_lshlrev_b32 v12, 3, v12
    buffer_store_dwordx2 v[14:15], v12, s[32:35], s38 offen
    s_nop 0
K1_OV0:
    s_mov_b64 exec, s[46:47]
    v_cmp_gt_u32 s[46:47], s42, v33
    v_cmp_lt_u32 vcc, 6, v49
    s_and_b64 vcc, vcc, s[46:47]
    s_and_saveexec_b64 s[46:47], vcc
    s_nop 2
    s_cbranch_execz K1_OV1
    v_lshl_add_u32 v12, v49, 2, v33
    v_subrev_u32 v12, 28, v12
    v_mov_b32 v13, 0x80000000
    v_cmp_gt_u32 vcc, 15, v49
    s_nop 1
    v_cndmask_b32 v12, v13, v12, vcc
    buffer_store_dword v41, v12, s[48:51], s39 offen
    s_andn2_b64 exec, exec, vcc
    s_cbranch_execz K1_OV1
    ds_add_rtn_u32 v12, v9, v7
    v_lshrrev_b32 v14, 5, v33
    v_mov_b32 v15, v41
    s_waitcnt lgkmcnt(0)
    v_lshlrev_b32 v12, 3, v12
    buffer_store_dwordx2 v[14:15], v12, s[32:35], s38 offen
    s_nop 0
K1_OV1:
    s_mov_b64 exec, s[46:47]
    v_cmp_gt_u32 s[46:47], s42, v34
    v_cmp_lt_u32 vcc, 6, v50
    s_and_b64 vcc, vcc, s[46:47]
    s_and_saveexec_b64 s[46:47], vcc
    s_nop 2
    s_cbranch_execz K1_OV2
    v_lshl_add_u32 v12, v50, 2, v34
    v_subrev_u32 v12, 28, v12
    v_mov_b32 v13, 0x80000000
    v_cmp_gt_u32 vcc, 15, v50
    s_nop 1
    v_cndmask_b32 v12, v13, v12, vcc
    buffer_store_dword v42, v12, s[48:51], s39 offen
    s_andn2_b64 exec, exec, vcc
    s_cbranch_execz K1_OV2
    ds_add_rtn_u32 v12, v9, v7
    v_lshrrev_b32 v14, 5, v34
    v_mov_b32 v15, v42
    s_waitcnt lgkmcnt(0)
    v_lshlrev_b32 v12, 3, v12
    buffer_store_dwordx2 v[14:15], v12, s[32:35], s38 offen
    s_nop 0
K1_OV2:
    s_mov_b64 exec, s[46:47]
    v_cmp_gt_u32 s[46:47], s42, v35
    v_cmp_lt_u32 vcc, 6, v51
    s_and_b64 vcc, vcc, s[46:47]
    s_and_saveexec_b64 s[46:47], vcc
    s_nop 2
    s_cbranch_execz K1_OV3
    v_lshl_add_u32 v12, v51, 2, v35
    v_subrev_u32 v12, 28, v12
    v_mov_b32 v13, 0x80000000
    v_cmp_gt_u32 vcc, 15, v51
    s_nop 1
    v_cndmask_b32 v12, v13, v12, vcc
    buffer_store_dword v43, v12, s[48:51], s39 offen
    s_andn2_b64 exec, exec, vcc
    s_cbranch_execz K1_OV3
    ds_add_rtn_u32 v12, v9, v7
    v_lshrrev_b32 v14, 5, v35
    v_mov_b32 v15, v43
    s_waitcnt lgkmcnt(0)
    v_lshlrev_b32 v12, 3, v12
    buffer_store_dwordx2 v[14:15], v12, s[32:35], s38 offen
    s_nop 0
K1_OV3:
    s_mov_b64 exec, s[46:47]
    v_cmp_gt_u32 s[46:47], s42, v36
    v_cmp_lt_u32 vcc, 6, v52
    s_and_b64 vcc, vcc, s[46:47]
    s_and_saveexec_b64 s[46:47], vcc
    s_nop 2
    s_cbranch_execz K1_OV4
    v_lshl_add_u32 v12, v52, 2, v36
    v_subrev_u32 v12, 28, v12
    v_mov_b32 v13, 0x80000000
    v_cmp_gt_u32 vcc, 15, v52
    s_nop 1
    v_cndmask_b32 v12, v13, v12, vcc
    buffer_store_dword v44, v12, s[48:51], s39 offen
    s_andn2_b64 exec, exec, vcc
    s_cbranch_execz K1_OV4
    ds_add_rtn_u32 v12, v9, v7
    v_lshrrev_b32 v14, 5, v36
    v_mov_b32 v15, v44
    s_waitcnt lgkmcnt(0)
    v_lshlrev_b32 v12, 3, v12
    buffer_store_dwordx2 v[14:15], v12, s[32:35], s38 offen
    s_nop 0
K1_OV4:
    s_mov_b64 exec, s[46:47]
    v_cmp_gt_u32 s[46:47], s42, v37
    v_cmp_lt_u32 vcc, 6, v53
    s_and_b64 vcc, vcc, s[46:47]
    s_and_saveexec_b64 s[46:47], vcc
    s_nop 2
    s_cbranch_execz K1_OV5
    v_lshl_add_u32 v12, v53, 2, v37
    v_subrev_u32 v12, 28, v12
    v_mov_b32 v13, 0x80000000
    v_cmp_gt_u32 vcc, 15, v53
    s_nop 1
    v_cndmask_b32 v12, v13, v12, vcc
    buffer_store_dword v45, v12, s[48:51], s39 offen
    s_andn2_b64 exec, exec, vcc
    s_cbranch_execz K1_OV5
    ds_add_rtn_u32 v12, v9, v7
    v_lshrrev_b32 v14, 5, v37
    v_mov_b32 v15, v45
    s_waitcnt lgkmcnt(0)
    v_lshlrev_b32 v12, 3, v12
    buffer_store_dwordx2 v[14:15], v12, s[32:35], s38 offen
    s_nop 0
K1_OV5:
    s_mov_b64 exec, s[46:47]
    v_cmp_gt_u32 s[46:47], s42, v38
    v_cmp_lt_u32 vcc, 6, v54
    s_and_b64 vcc, vcc, s[46:47]
    s_and_saveexec_b64 s[46:47], vcc
    s_nop 2
    s_cbranch_execz K1_OV6
    v_lshl_add_u32 v12, v54, 2, v38
    v_subrev_u32 v12, 28, v12
    v_mov_b32 v13, 0x80000000
    v_cmp_gt_u32 vcc, 15, v54
    s_nop 1
    v_cndmask_b32 v12, v13, v12, vcc
    buffer_store_dword v46, v12, s[48:51], s39 offen
    s_andn2_b64 exec, exec, vcc
    s_cbranch_execz K1_OV6
    ds_add_rtn_u32 v12, v9, v7
    v_lshrrev_b32 v14, 5, v38
    v_mov_b32 v15, v46
    s_waitcnt lgkmcnt(0)
    v_lshlrev_b32 v12, 3, v12
    buffer_store_dwordx2 v[14:15], v12, s[32:35], s38 offen
    s_nop 0
K1_OV6:
    s_mov_b64 exec, s[46:47]
K1_NOOVF:
    s_waitcnt lgkmcnt(0)
    s_barrier
    v_lshlrev_b32 v6, 4, v0
    ds_read_b128 v[16:19], v6 offset:0
    ds_read_b128 v[20:23], v6 offset:4096
    ds_read_b128 v[24:27], v6 offset:8192
    ds_read_b128 v[28:31], v6 offset:12288
    ds_read_b128 v[32:35], v6 offset:16384
    ds_read_b128 v[36:39], v6 offset:20480
    ds_read_b128 v[40:43], v6 offset:24576
    ds_read_b128 v[44:47], v6 offset:28672
    ds_read_b32 v9, v9
    s_mul_i32 s38, s2, 32896
    s_waitcnt lgkmcnt(8)
    buffer_store_dwordx4 v[16:19], v6, s[28:31], s38 offen
    s_nop 0
    s_add_u32 s38, s38, 4096
    s_waitcnt lgkmcnt(7)
    buffer_store_dwordx4 v[20:23], v6, s[28:31], s38 offen
    s_nop 0
    s_add_u32 s38, s38, 4096
    s_waitcnt lgkmcnt(6)
    buffer_store_dwordx4 v[24:27], v6, s[28:31], s38 offen
    s_nop 0
    s_add_u32 s38, s38, 4096
    s_waitcnt lgkmcnt(5)
    buffer_store_dwordx4 v[28:31], v6, s[28:31], s38 offen
    s_nop 0
    s_add_u32 s38, s38, 4096
    s_waitcnt lgkmcnt(4)
    buffer_store_dwordx4 v[32:35], v6, s[28:31], s38 offen
    s_nop 0
    s_add_u32 s38, s38, 4096
    s_waitcnt lgkmcnt(3)
    buffer_store_dwordx4 v[36:39], v6, s[28:31], s38 offen
    s_nop 0
    s_add_u32 s38, s38, 4096
    s_waitcnt lgkmcnt(2)
    buffer_store_dwordx4 v[40:43], v6, s[28:31], s38 offen
    s_nop 0
    s_add_u32 s38, s38, 4096
    s_waitcnt lgkmcnt(1)
    buffer_store_dwordx4 v[44:47], v6, s[28:31], s38 offen
    s_waitcnt lgkmcnt(0)
    s_add_u32 s32, s18, 0x692000
    s_addc_u32 s33, s19, 0
    s_mov_b32 s34, 0x400
    s_mov_b32 s35, 0x00020000
    s_lshl_b32 s38, s2, 2
    v_mov_b32 v10, 0x80000000
    v_cmp_eq_u32 vcc, 0, v0
    s_nop 1
    v_cndmask_b32 v10, v10, v8, vcc
    buffer_store_dword v9, v10, s[32:35], s38 offen
    s_endpgm
K1_GEMM:
    s_cmp_ge_u32 s2, 675
    s_cbranch_scc1 K1_MISC
    s_sub_u32 s36, s2, 256
    s_mov_b32 s37, 0
    s_cmp_ge_u32 s36, 98
    s_cbranch_scc0 K1_MSEL
    s_sub_u32 s36, s36, 98
    s_add_u32 s37, s37, 1
    s_cmp_ge_u32 s36, 98
    s_cbranch_scc0 K1_MSEL
    s_sub_u32 s36, s36, 98
    s_add_u32 s37, s37, 1
    s_cmp_ge_u32 s36, 98
    s_cbranch_scc0 K1_MSEL
    s_sub_u32 s36, s36, 98
    s_add_u32 s37, s37, 1
K1_MSEL:
    s_add_u32 s20, s16, 0x8000
    s_addc_u32 s21, s17, 0
    s_cmp_eq_u32 s37, 1
    s_cselect_b32 s20, s14, s20
    s_cselect_b32 s21, s15, s21
    s_cmp_eq_u32 s37, 2
    s_cselect_b32 s20, s12, s20
    s_cselect_b32 s21, s13, s21
    s_cmp_eq_u32 s37, 3
    s_cselect_b32 s20, s16, s20
    s_cselect_b32 s21, s17, s21
    s_mov_b32 s22, 0x8000
    s_mov_b32 s23, 0x00020000
    s_mov_b32 s24, s4
    s_mov_b32 s25, s5
    s_mov_b32 s26, 0x30d400
    s_mov_b32 s27, 0x00020000
    s_mov_b32 s40, 0x05040100
    s_mov_b32 s41, 0x07060302
    v_lshlrev_b32 v5, 11, v3
    v_lshl_add_u32 v5, v4, 4, v5
    s_lshl_b32 s42, s3, 13
    buffer_load_dwordx4 v[64:67], v5, s[20:23], s42 offen offset:0
    buffer_load_dwordx4 v[68:71], v5, s[20:23], s42 offen offset:256
    buffer_load_dwordx4 v[72:75], v5, s[20:23], s42 offen offset:512
    buffer_load_dwordx4 v[76:79], v5, s[20:23], s42 offen offset:768
    buffer_load_dwordx4 v[80:83], v5, s[20:23], s42 offen offset:1024
    buffer_load_dwordx4 v[84:87], v5, s[20:23], s42 offen offset:1280
    buffer_load_dwordx4 v[88:91], v5, s[20:23], s42 offen offset:1536
    buffer_load_dwordx4 v[92:95], v5, s[20:23], s42 offen offset:1792
    s_lshl_b32 s44, s36, 3
    s_lshl_b32 s45, s3, 1
    s_add_u32 s44, s44, s45
    s_add_u32 s45, s44, 1
    s_lshl_b32 s46, s44, 4
    s_lshl_b32 s47, s45, 4
    s_mul_i32 s48, s44, 25
    s_add_u32 s48, s48, 1
    s_lshr_b32 s48, s48, 1
    s_mul_i32 s49, s45, 25
    s_add_u32 s49, s49, 1
    s_lshr_b32 s49, s49, 1
    s_cmp_eq_u32 s37, 3
    s_cselect_b32 s46, s48, s46
    s_cselect_b32 s47, s49, s47
    v_lshlrev_b32 v6, 8, v4
    v_lshl_add_u32 v6, v3, 4, v6
    s_lshl_b32 s48, s46, 8
    s_lshl_b32 s49, s47, 8
    buffer_load_dwordx4 v[96:99], v6, s[24:27], s48 offen offset:0
    buffer_load_dwordx4 v[100:103], v6, s[24:27], s48 offen offset:64
    buffer_load_dwordx4 v[104:107], v6, s[24:27], s48 offen offset:128
    buffer_load_dwordx4 v[108:111], v6, s[24:27], s48 offen offset:192
    buffer_load_dwordx4 v[112:115], v6, s[24:27], s49 offen offset:0
    buffer_load_dwordx4 v[116:119], v6, s[24:27], s49 offen offset:64
    buffer_load_dwordx4 v[120:123], v6, s[24:27], s49 offen offset:128
    buffer_load_dwordx4 v[124:127], v6, s[24:27], s49 offen offset:192
    v_lshlrev_b32 v7, 4, v2
    v_add_u32 v8, s42, v7
    s_waitcnt vmcnt(8)
    v_perm_b32 v12, v68, v64, s40
    v_perm_b32 v13, v76, v72, s40
    v_perm_b32 v14, v84, v80, s40
    v_perm_b32 v15, v92, v88, s40
    ds_write_b128 v8, v[12:15] offset:0
    v_perm_b32 v16, v68, v64, s41
    v_perm_b32 v17, v76, v72, s41
    v_perm_b32 v18, v84, v80, s41
    v_perm_b32 v19, v92, v88, s41
    ds_write_b128 v8, v[16:19] offset:1024
    v_perm_b32 v12, v69, v65, s40
    v_perm_b32 v13, v77, v73, s40
    v_perm_b32 v14, v85, v81, s40
    v_perm_b32 v15, v93, v89, s40
    ds_write_b128 v8, v[12:15] offset:2048
    v_perm_b32 v16, v69, v65, s41
    v_perm_b32 v17, v77, v73, s41
    v_perm_b32 v18, v85, v81, s41
    v_perm_b32 v19, v93, v89, s41
    ds_write_b128 v8, v[16:19] offset:3072
    v_perm_b32 v12, v70, v66, s40
    v_perm_b32 v13, v78, v74, s40
    v_perm_b32 v14, v86, v82, s40
    v_perm_b32 v15, v94, v90, s40
    ds_write_b128 v8, v[12:15] offset:4096
    v_perm_b32 v16, v70, v66, s41
    v_perm_b32 v17, v78, v74, s41
    v_perm_b32 v18, v86, v82, s41
    v_perm_b32 v19, v94, v90, s41
    ds_write_b128 v8, v[16:19] offset:5120
    v_perm_b32 v12, v71, v67, s40
    v_perm_b32 v13, v79, v75, s40
    v_perm_b32 v14, v87, v83, s40
    v_perm_b32 v15, v95, v91, s40
    ds_write_b128 v8, v[12:15] offset:6144
    v_perm_b32 v16, v71, v67, s41
    v_perm_b32 v17, v79, v75, s41
    v_perm_b32 v18, v87, v83, s41
    v_perm_b32 v19, v95, v91, s41
    ds_write_b128 v8, v[16:19] offset:7168
    s_waitcnt lgkmcnt(0)
    s_barrier
    s_add_u32 s28, s18, 0x0
    s_addc_u32 s29, s19, 0
    s_mov_b32 s30, 0x61a800
    s_mov_b32 s43, 9
    s_mov_b32 s31, 0x00020000
    s_mov_b32 s51, 0xbfb8aa3b
    s_cmp_eq_u32 s37, 1
    s_cbranch_scc0 K1_G1
    s_add_u32 s28, s28, 256
    s_addc_u32 s29, s29, 0
    s_mov_b32 s30, 0x61a700
    s_mov_b32 s51, 1.0
K1_G1:
    s_cmp_eq_u32 s37, 2
    s_cbranch_scc0 K1_G2
    s_add_u32 s28, s18, 0x1c00000
    s_addc_u32 s29, s19, 0
    s_mov_b32 s30, 0x30d400
    s_mov_b32 s43, 8
    s_mov_b32 s51, 1.0
K1_G2:
    s_cmp_eq_u32 s37, 3
    s_cbranch_scc0 K1_G3
    s_add_u32 s28, s18, 0x2000000
    s_addc_u32 s29, s19, 0
    s_mov_b32 s30, 0x3e8000
K1_G3:
    v_mov_b32 v20, 0
    v_mov_b32 v21, 0
    v_mov_b32 v22, 0
    v_mov_b32 v23, 0
    v_mov_b32 v24, 0
    v_mov_b32 v25, 0
    v_mov_b32 v26, 0
    v_mov_b32 v27, 0
    v_mov_b32 v28, 0
    v_mov_b32 v29, 0
    v_mov_b32 v30, 0
    v_mov_b32 v31, 0
    v_mov_b32 v32, 0
    v_mov_b32 v33, 0
    v_mov_b32 v34, 0
    v_mov_b32 v35, 0
    v_mov_b32 v36, 0
    v_mov_b32 v37, 0
    v_mov_b32 v38, 0
    v_mov_b32 v39, 0
    v_mov_b32 v40, 0
    v_mov_b32 v41, 0
    v_mov_b32 v42, 0
    v_mov_b32 v43, 0
    v_mov_b32 v44, 0
    v_mov_b32 v45, 0
    v_mov_b32 v46, 0
    v_mov_b32 v47, 0
    v_mov_b32 v48, 0
    v_mov_b32 v49, 0
    v_mov_b32 v50, 0
    v_mov_b32 v51, 0
    v_mov_b32 v64, 0
    v_mov_b32 v65, 0
    v_mov_b32 v66, 0
    v_mov_b32 v67, 0
    v_mov_b32 v68, 0
    v_mov_b32 v69, 0
    v_mov_b32 v70, 0
    v_mov_b32 v71, 0
    v_mov_b32 v72, 0
    v_mov_b32 v73, 0
    v_mov_b32 v74, 0
    v_mov_b32 v75, 0
    v_mov_b32 v76, 0
    v_mov_b32 v77, 0
    v_mov_b32 v78, 0
    v_mov_b32 v79, 0
    v_mov_b32 v80, 0
    v_mov_b32 v81, 0
    v_mov_b32 v82, 0
    v_mov_b32 v83, 0
    v_mov_b32 v84, 0
    v_mov_b32 v85, 0
    v_mov_b32 v86, 0
    v_mov_b32 v87, 0
    v_mov_b32 v88, 0
    v_mov_b32 v89, 0
    v_mov_b32 v90, 0
    v_mov_b32 v91, 0
    v_mov_b32 v92, 0
    v_mov_b32 v93, 0
    v_mov_b32 v94, 0
    v_mov_b32 v95, 0
    ds_read_b128 v[52:55], v7 offset:0
    ds_read_b128 v[56:59], v7 offset:1024
    ds_read_b128 v[60:63], v7 offset:2048
    ds_read_b128 v[12:15], v7 offset:3072
    s_waitcnt vmcnt(0)
    ds_read_b128 v[16:19], v7 offset:4096
    s_waitcnt lgkmcnt(4)
    v_mfma_f32_16x16x32_bf16 v[20:23], v[96:99], v[52:55], v[20:23]
    v_mfma_f32_16x16x32_bf16 v[64:67], v[112:115], v[52:55], v[64:67]
    ds_read_b128 v[52:55], v7 offset:5120
    s_waitcnt lgkmcnt(4)
    v_mfma_f32_16x16x32_bf16 v[24:27], v[96:99], v[56:59], v[24:27]
    v_mfma_f32_16x16x32_bf16 v[68:71], v[112:115], v[56:59], v[68:71]
    ds_read_b128 v[56:59], v7 offset:6144
    s_waitcnt lgkmcnt(4)
    v_mfma_f32_16x16x32_bf16 v[28:31], v[96:99], v[60:63], v[28:31]
    v_mfma_f32_16x16x32_bf16 v[72:75], v[112:115], v[60:63], v[72:75]
    ds_read_b128 v[60:63], v7 offset:7168
    s_waitcnt lgkmcnt(4)
    v_mfma_f32_16x16x32_bf16 v[32:35], v[96:99], v[12:15], v[32:35]
    v_mfma_f32_16x16x32_bf16 v[76:79], v[112:115], v[12:15], v[76:79]
    ds_read_b128 v[12:15], v7 offset:8192
    s_waitcnt lgkmcnt(4)
    v_mfma_f32_16x16x32_bf16 v[36:39], v[96:99], v[16:19], v[36:39]
    v_mfma_f32_16x16x32_bf16 v[80:83], v[112:115], v[16:19], v[80:83]
    ds_read_b128 v[16:19], v7 offset:9216
    s_waitcnt lgkmcnt(4)
    v_mfma_f32_16x16x32_bf16 v[40:43], v[96:99], v[52:55], v[40:43]
    v_mfma_f32_16x16x32_bf16 v[84:87], v[112:115], v[52:55], v[84:87]
    ds_read_b128 v[52:55], v7 offset:10240
    s_waitcnt lgkmcnt(4)
    v_mfma_f32_16x16x32_bf16 v[44:47], v[96:99], v[56:59], v[44:47]
    v_mfma_f32_16x16x32_bf16 v[88:91], v[112:115], v[56:59], v[88:91]
    ds_read_b128 v[56:59], v7 offset:11264
    s_waitcnt lgkmcnt(4)
    v_mfma_f32_16x16x32_bf16 v[48:51], v[96:99], v[60:63], v[48:51]
    v_mfma_f32_16x16x32_bf16 v[92:95], v[112:115], v[60:63], v[92:95]
    ds_read_b128 v[60:63], v7 offset:12288
    s_waitcnt lgkmcnt(4)
    v_mfma_f32_16x16x32_bf16 v[20:23], v[100:103], v[12:15], v[20:23]
    v_mfma_f32_16x16x32_bf16 v[64:67], v[116:119], v[12:15], v[64:67]
    ds_read_b128 v[12:15], v7 offset:13312
    s_waitcnt lgkmcnt(4)
    v_mfma_f32_16x16x32_bf16 v[24:27], v[100:103], v[16:19], v[24:27]
    v_mfma_f32_16x16x32_bf16 v[68:71], v[116:119], v[16:19], v[68:71]
    ds_read_b128 v[16:19], v7 offset:14336
    s_waitcnt lgkmcnt(4)
    v_mfma_f32_16x16x32_bf16 v[28:31], v[100:103], v[52:55], v[28:31]
    v_mfma_f32_16x16x32_bf16 v[72:75], v[116:119], v[52:55], v[72:75]
    ds_read_b128 v[52:55], v7 offset:15360
    s_waitcnt lgkmcnt(4)
    v_mfma_f32_16x16x32_bf16 v[32:35], v[100:103], v[56:59], v[32:35]
    v_mfma_f32_16x16x32_bf16 v[76:79], v[116:119], v[56:59], v[76:79]
    ds_read_b128 v[56:59], v7 offset:16384
    s_waitcnt lgkmcnt(4)
    v_mfma_f32_16x16x32_bf16 v[36:39], v[100:103], v[60:63], v[36:39]
    v_mfma_f32_16x16x32_bf16 v[80:83], v[116:119], v[60:63], v[80:83]
    ds_read_b128 v[60:63], v7 offset:17408
    s_waitcnt lgkmcnt(4)
    v_mfma_f32_16x16x32_bf16 v[40:43], v[100:103], v[12:15], v[40:43]
    v_mfma_f32_16x16x32_bf16 v[84:87], v[116:119], v[12:15], v[84:87]
    ds_read_b128 v[12:15], v7 offset:18432
    s_waitcnt lgkmcnt(4)
    v_mfma_f32_16x16x32_bf16 v[44:47], v[100:103], v[16:19], v[44:47]
    v_mfma_f32_16x16x32_bf16 v[88:91], v[116:119], v[16:19], v[88:91]
    ds_read_b128 v[16:19], v7 offset:19456
    s_waitcnt lgkmcnt(4)
    v_mfma_f32_16x16x32_bf16 v[48:51], v[100:103], v[52:55], v[48:51]
    v_mfma_f32_16x16x32_bf16 v[92:95], v[116:119], v[52:55], v[92:95]
    ds_read_b128 v[52:55], v7 offset:20480
    s_waitcnt lgkmcnt(4)
    v_mfma_f32_16x16x32_bf16 v[20:23], v[104:107], v[56:59], v[20:23]
    v_mfma_f32_16x16x32_bf16 v[64:67], v[120:123], v[56:59], v[64:67]
    ds_read_b128 v[56:59], v7 offset:21504
    s_waitcnt lgkmcnt(4)
    v_mfma_f32_16x16x32_bf16 v[24:27], v[104:107], v[60:63], v[24:27]
    v_mfma_f32_16x16x32_bf16 v[68:71], v[120:123], v[60:63], v[68:71]
    ds_read_b128 v[60:63], v7 offset:22528
    s_waitcnt lgkmcnt(4)
    v_mfma_f32_16x16x32_bf16 v[28:31], v[104:107], v[12:15], v[28:31]
    v_mfma_f32_16x16x32_bf16 v[72:75], v[120:123], v[12:15], v[72:75]
    ds_read_b128 v[12:15], v7 offset:23552
    s_waitcnt lgkmcnt(4)
    v_mfma_f32_16x16x32_bf16 v[32:35], v[104:107], v[16:19], v[32:35]
    v_mfma_f32_16x16x32_bf16 v[76:79], v[120:123], v[16:19], v[76:79]
    ds_read_b128 v[16:19], v7 offset:24576
    s_waitcnt lgkmcnt(4)
    v_mfma_f32_16x16x32_bf16 v[36:39], v[104:107], v[52:55], v[36:39]
    v_mfma_f32_16x16x32_bf16 v[80:83], v[120:123], v[52:55], v[80:83]
    ds_read_b128 v[52:55], v7 offset:25600
    s_waitcnt lgkmcnt(4)
    v_mfma_f32_16x16x32_bf16 v[40:43], v[104:107], v[56:59], v[40:43]
    v_mfma_f32_16x16x32_bf16 v[84:87], v[120:123], v[56:59], v[84:87]
    ds_read_b128 v[56:59], v7 offset:26624
    s_waitcnt lgkmcnt(4)
    v_mfma_f32_16x16x32_bf16 v[44:47], v[104:107], v[60:63], v[44:47]
    v_mfma_f32_16x16x32_bf16 v[88:91], v[120:123], v[60:63], v[88:91]
    ds_read_b128 v[60:63], v7 offset:27648
    s_waitcnt lgkmcnt(4)
    v_mfma_f32_16x16x32_bf16 v[48:51], v[104:107], v[12:15], v[48:51]
    v_mfma_f32_16x16x32_bf16 v[92:95], v[120:123], v[12:15], v[92:95]
    ds_read_b128 v[12:15], v7 offset:28672
    s_waitcnt lgkmcnt(4)
    v_mfma_f32_16x16x32_bf16 v[20:23], v[108:111], v[16:19], v[20:23]
    v_mfma_f32_16x16x32_bf16 v[64:67], v[124:127], v[16:19], v[64:67]
    ds_read_b128 v[16:19], v7 offset:29696
    s_waitcnt lgkmcnt(4)
    v_mfma_f32_16x16x32_bf16 v[24:27], v[108:111], v[52:55], v[24:27]
    v_mfma_f32_16x16x32_bf16 v[68:71], v[124:127], v[52:55], v[68:71]
    ds_read_b128 v[52:55], v7 offset:30720
    s_waitcnt lgkmcnt(4)
    v_mfma_f32_16x16x32_bf16 v[28:31], v[108:111], v[56:59], v[28:31]
    v_mfma_f32_16x16x32_bf16 v[72:75], v[124:127], v[56:59], v[72:75]
    ds_read_b128 v[56:59], v7 offset:31744
    s_waitcnt lgkmcnt(4)
    v_mfma_f32_16x16x32_bf16 v[32:35], v[108:111], v[60:63], v[32:35]
    v_mfma_f32_16x16x32_bf16 v[76:79], v[124:127], v[60:63], v[76:79]
    s_waitcnt lgkmcnt(3)
    v_mfma_f32_16x16x32_bf16 v[36:39], v[108:111], v[12:15], v[36:39]
    v_mfma_f32_16x16x32_bf16 v[80:83], v[124:127], v[12:15], v[80:83]
    s_waitcnt lgkmcnt(2)
    v_mfma_f32_16x16x32_bf16 v[40:43], v[108:111], v[16:19], v[40:43]
    v_mfma_f32_16x16x32_bf16 v[84:87], v[124:127], v[16:19], v[84:87]
    s_waitcnt lgkmcnt(1)
    v_mfma_f32_16x16x32_bf16 v[44:47], v[108:111], v[52:55], v[44:47]
    v_mfma_f32_16x16x32_bf16 v[88:91], v[124:127], v[52:55], v[88:91]
    s_waitcnt lgkmcnt(0)
    v_mfma_f32_16x16x32_bf16 v[48:51], v[108:111], v[56:59], v[48:51]
    v_mfma_f32_16x16x32_bf16 v[92:95], v[124:127], v[56:59], v[92:95]
    v_mul_f32 v20, s51, v20
    v_mul_f32 v21, s51, v21
    v_mul_f32 v22, s51, v22
    v_mul_f32 v23, s51, v23
    v_mul_f32 v24, s51, v24
    v_mul_f32 v25, s51, v25
    v_mul_f32 v26, s51, v26
    v_mul_f32 v27, s51, v27
    v_mul_f32 v28, s51, v28
    v_mul_f32 v29, s51, v29
    v_mul_f32 v30, s51, v30
    v_mul_f32 v31, s51, v31
    v_mul_f32 v32, s51, v32
    v_mul_f32 v33, s51, v33
    v_mul_f32 v34, s51, v34
    v_mul_f32 v35, s51, v35
    v_mul_f32 v36, s51, v36
    v_mul_f32 v37, s51, v37
    v_mul_f32 v38, s51, v38
    v_mul_f32 v39, s51, v39
    v_mul_f32 v40, s51, v40
    v_mul_f32 v41, s51, v41
    v_mul_f32 v42, s51, v42
    v_mul_f32 v43, s51, v43
    v_mul_f32 v44, s51, v44
    v_mul_f32 v45, s51, v45
    v_mul_f32 v46, s51, v46
    v_mul_f32 v47, s51, v47
    v_mul_f32 v48, s51, v48
    v_mul_f32 v49, s51, v49
    v_mul_f32 v50, s51, v50
    v_mul_f32 v51, s51, v51
    v_mul_f32 v64, s51, v64
    v_mul_f32 v65, s51, v65
    v_mul_f32 v66, s51, v66
    v_mul_f32 v67, s51, v67
    v_mul_f32 v68, s51, v68
    v_mul_f32 v69, s51, v69
    v_mul_f32 v70, s51, v70
    v_mul_f32 v71, s51, v71
    v_mul_f32 v72, s51, v72
    v_mul_f32 v73, s51, v73
    v_mul_f32 v74, s51, v74
    v_mul_f32 v75, s51, v75
    v_mul_f32 v76, s51, v76
    v_mul_f32 v77, s51, v77
    v_mul_f32 v78, s51, v78
    v_mul_f32 v79, s51, v79
    v_mul_f32 v80, s51, v80
    v_mul_f32 v81, s51, v81
    v_mul_f32 v82, s51, v82
    v_mul_f32 v83, s51, v83
    v_mul_f32 v84, s51, v84
    v_mul_f32 v85, s51, v85
    v_mul_f32 v86, s51, v86
    v_mul_f32 v87, s51, v87
    v_mul_f32 v88, s51, v88
    v_mul_f32 v89, s51, v89
    v_mul_f32 v90, s51, v90
    v_mul_f32 v91, s51, v91
    v_mul_f32 v92, s51, v92
    v_mul_f32 v93, s51, v93
    v_mul_f32 v94, s51, v94
    v_mul_f32 v95, s51, v95
    s_cmp_eq_u32 s37, 3
    s_nop 0
    s_cbranch_scc1 K1_EA
    v_mov_b32 v9, 1
    v_lshlrev_b32 v9, s43, v9
    v_lshl_add_u32 v8, v3, 2, s46
    v_lshlrev_b32 v8, s43, v8
    v_lshl_add_u32 v8, v4, 4, v8
    v_cvt_pk_bf16_f32 v96, v20, v24
    v_cvt_pk_bf16_f32 v97, v28, v32
    v_cvt_pk_bf16_f32 v98, v36, v40
    v_cvt_pk_bf16_f32 v99, v44, v48
    buffer_store_dwordx4 v[96:99], v8, s[28:31], 0 offen
    s_nop 1
    v_add_u32 v8, v8, v9
    v_cvt_pk_bf16_f32 v100, v21, v25
    v_cvt_pk_bf16_f32 v101, v29, v33
    v_cvt_pk_bf16_f32 v102, v37, v41
    v_cvt_pk_bf16_f32 v103, v45, v49
    buffer_store_dwordx4 v[100:103], v8, s[28:31], 0 offen
    s_nop 1
    v_add_u32 v8, v8, v9
    v_cvt_pk_bf16_f32 v96, v22, v26
    v_cvt_pk_bf16_f32 v97, v30, v34
    v_cvt_pk_bf16_f32 v98, v38, v42
    v_cvt_pk_bf16_f32 v99, v46, v50
    buffer_store_dwordx4 v[96:99], v8, s[28:31], 0 offen
    s_nop 1
    v_add_u32 v8, v8, v9
    v_cvt_pk_bf16_f32 v100, v23, v27
    v_cvt_pk_bf16_f32 v101, v31, v35
    v_cvt_pk_bf16_f32 v102, v39, v43
    v_cvt_pk_bf16_f32 v103, v47, v51
    buffer_store_dwordx4 v[100:103], v8, s[28:31], 0 offen
    s_nop 1
    v_lshl_add_u32 v8, v3, 2, s47
    v_lshlrev_b32 v8, s43, v8
    v_lshl_add_u32 v8, v4, 4, v8
    v_cvt_pk_bf16_f32 v104, v64, v68
    v_cvt_pk_bf16_f32 v105, v72, v76
    v_cvt_pk_bf16_f32 v106, v80, v84
    v_cvt_pk_bf16_f32 v107, v88, v92
    buffer_store_dwordx4 v[104:107], v8, s[28:31], 0 offen
    s_nop 1
    v_add_u32 v8, v8, v9
    v_cvt_pk_bf16_f32 v108, v65, v69
    v_cvt_pk_bf16_f32 v109, v73, v77
    v_cvt_pk_bf16_f32 v110, v81, v85
    v_cvt_pk_bf16_f32 v111, v89, v93
    buffer_store_dwordx4 v[108:111], v8, s[28:31], 0 offen
    s_nop 1
    v_add_u32 v8, v8, v9
    v_cvt_pk_bf16_f32 v104, v66, v70
    v_cvt_pk_bf16_f32 v105, v74, v78
    v_cvt_pk_bf16_f32 v106, v82, v86
    v_cvt_pk_bf16_f32 v107, v90, v94
    buffer_store_dwordx4 v[104:107], v8, s[28:31], 0 offen
    s_nop 1
    v_add_u32 v8, v8, v9
    v_cvt_pk_bf16_f32 v108, v67, v71
    v_cvt_pk_bf16_f32 v109, v75, v79
    v_cvt_pk_bf16_f32 v110, v83, v87
    v_cvt_pk_bf16_f32 v111, v91, v95
    buffer_store_dwordx4 v[108:111], v8, s[28:31], 0 offen
    s_endpgm
    s_nop 0
K1_EA:
    v_lshrrev_b32 v9, 1, v3
    v_lshl_add_u32 v9, v9, 4, v4
    v_lshlrev_b32 v9, 4, v9
    v_and_b32 v10, 1, v3
    v_lshl_add_u32 v9, v10, 3, v9
    s_lshl_b32 s50, s44, 12
    v_cvt_pk_bf16_f32 v96, v20, v21
    v_cvt_pk_bf16_f32 v97, v22, v23
    buffer_store_dwordx2 v[96:97], v9, s[28:31], s50 offen offset:0
    v_cvt_pk_bf16_f32 v98, v24, v25
    v_cvt_pk_bf16_f32 v99, v26, v27
    buffer_store_dwordx2 v[98:99], v9, s[28:31], s50 offen offset:512
    v_cvt_pk_bf16_f32 v100, v28, v29
    v_cvt_pk_bf16_f32 v101, v30, v31
    buffer_store_dwordx2 v[100:101], v9, s[28:31], s50 offen offset:1024
    v_cvt_pk_bf16_f32 v102, v32, v33
    v_cvt_pk_bf16_f32 v103, v34, v35
    buffer_store_dwordx2 v[102:103], v9, s[28:31], s50 offen offset:1536
    v_cvt_pk_bf16_f32 v96, v36, v37
    v_cvt_pk_bf16_f32 v97, v38, v39
    buffer_store_dwordx2 v[96:97], v9, s[28:31], s50 offen offset:2048
    v_cvt_pk_bf16_f32 v98, v40, v41
    v_cvt_pk_bf16_f32 v99, v42, v43
    buffer_store_dwordx2 v[98:99], v9, s[28:31], s50 offen offset:2560
    v_cvt_pk_bf16_f32 v100, v44, v45
    v_cvt_pk_bf16_f32 v101, v46, v47
    buffer_store_dwordx2 v[100:101], v9, s[28:31], s50 offen offset:3072
    v_cvt_pk_bf16_f32 v102, v48, v49
    v_cvt_pk_bf16_f32 v103, v50, v51
    buffer_store_dwordx2 v[102:103], v9, s[28:31], s50 offen offset:3584
    s_lshl_b32 s50, s45, 12
    v_cvt_pk_bf16_f32 v104, v64, v65
    v_cvt_pk_bf16_f32 v105, v66, v67
    buffer_store_dwordx2 v[104:105], v9, s[28:31], s50 offen offset:0
    v_cvt_pk_bf16_f32 v106, v68, v69
    v_cvt_pk_bf16_f32 v107, v70, v71
    buffer_store_dwordx2 v[106:107], v9, s[28:31], s50 offen offset:512
    v_cvt_pk_bf16_f32 v108, v72, v73
    v_cvt_pk_bf16_f32 v109, v74, v75
    buffer_store_dwordx2 v[108:109], v9, s[28:31], s50 offen offset:1024
    v_cvt_pk_bf16_f32 v110, v76, v77
    v_cvt_pk_bf16_f32 v111, v78, v79
    buffer_store_dwordx2 v[110:111], v9, s[28:31], s50 offen offset:1536
    v_cvt_pk_bf16_f32 v104, v80, v81
    v_cvt_pk_bf16_f32 v105, v82, v83
    buffer_store_dwordx2 v[104:105], v9, s[28:31], s50 offen offset:2048
    v_cvt_pk_bf16_f32 v106, v84, v85
    v_cvt_pk_bf16_f32 v107, v86, v87
    buffer_store_dwordx2 v[106:107], v9, s[28:31], s50 offen offset:2560
    v_cvt_pk_bf16_f32 v108, v88, v89
    v_cvt_pk_bf16_f32 v109, v90, v91
    buffer_store_dwordx2 v[108:109], v9, s[28:31], s50 offen offset:3072
    v_cvt_pk_bf16_f32 v110, v92, v93
    v_cvt_pk_bf16_f32 v111, v94, v95
    buffer_store_dwordx2 v[110:111], v9, s[28:31], s50 offen offset:3584
    s_endpgm
K1_MISC:
    s_cmp_eq_u32 s3, 1
    s_cbranch_scc1 K1_OH
    s_cmp_eq_u32 s3, 0
    s_cbranch_scc0 K1_END
    s_add_u32 s20, s16, 0x10000
    s_addc_u32 s21, s17, 0
    s_mov_b32 s22, 0x1000
    s_mov_b32 s23, 0x00020000
    s_add_u32 s28, s18, 0x690000
    s_addc_u32 s29, s19, 0
    s_mov_b32 s30, 0x1000
    s_mov_b32 s31, 0x00020000
    s_mov_b32 s40, 0x05040100
    s_mov_b32 s41, 0x07060302
    v_lshlrev_b32 v5, 11, v3
    v_lshl_add_u32 v5, v4, 4, v5
    buffer_load_dwordx4 v[16:19], v5, s[20:23], 0 offen offset:0
    buffer_load_dwordx4 v[20:23], v5, s[20:23], 0 offen offset:256
    buffer_load_dwordx4 v[24:27], v5, s[20:23], 0 offen offset:512
    buffer_load_dwordx4 v[28:31], v5, s[20:23], 0 offen offset:768
    buffer_load_dwordx4 v[32:35], v5, s[20:23], 0 offen offset:1024
    buffer_load_dwordx4 v[36:39], v5, s[20:23], 0 offen offset:1280
    buffer_load_dwordx4 v[40:43], v5, s[20:23], 0 offen offset:1536
    buffer_load_dwordx4 v[44:47], v5, s[20:23], 0 offen offset:1792
    v_lshlrev_b32 v6, 4, v2
    v_mov_b32 v7, 0x80000000
    v_cmp_gt_u32 vcc, 32, v2
    s_nop 1
    v_cndmask_b32 v6, v7, v6, vcc
    s_waitcnt vmcnt(0)
    v_lshlrev_b32 v60, 16, v16
    v_and_b32 v61, 0xffff0000, v16
    v_mul_f32 v60, 0xbfb8aa3b, v60
    v_mul_f32 v61, 0xbfb8aa3b, v61
    v_cvt_pk_bf16_f32 v16, v60, v61
    v_lshlrev_b32 v60, 16, v17
    v_and_b32 v61, 0xffff0000, v17
    v_mul_f32 v60, 0xbfb8aa3b, v60
    v_mul_f32 v61, 0xbfb8aa3b, v61
    v_cvt_pk_bf16_f32 v17, v60, v61
    v_lshlrev_b32 v60, 16, v18
    v_and_b32 v61, 0xffff0000, v18
    v_mul_f32 v60, 0xbfb8aa3b, v60
    v_mul_f32 v61, 0xbfb8aa3b, v61
    v_cvt_pk_bf16_f32 v18, v60, v61
    v_lshlrev_b32 v60, 16, v19
    v_and_b32 v61, 0xffff0000, v19
    v_mul_f32 v60, 0xbfb8aa3b, v60
    v_mul_f32 v61, 0xbfb8aa3b, v61
    v_cvt_pk_bf16_f32 v19, v60, v61
    v_lshlrev_b32 v60, 16, v20
    v_and_b32 v61, 0xffff0000, v20
    v_mul_f32 v60, 0xbfb8aa3b, v60
    v_mul_f32 v61, 0xbfb8aa3b, v61
    v_cvt_pk_bf16_f32 v20, v60, v61
    v_lshlrev_b32 v60, 16, v21
    v_and_b32 v61, 0xffff0000, v21
    v_mul_f32 v60, 0xbfb8aa3b, v60
    v_mul_f32 v61, 0xbfb8aa3b, v61
    v_cvt_pk_bf16_f32 v21, v60, v61
    v_lshlrev_b32 v60, 16, v22
    v_and_b32 v61, 0xffff0000, v22
    v_mul_f32 v60, 0xbfb8aa3b, v60
    v_mul_f32 v61, 0xbfb8aa3b, v61
    v_cvt_pk_bf16_f32 v22, v60, v61
    v_lshlrev_b32 v60, 16, v23
    v_and_b32 v61, 0xffff0000, v23
    v_mul_f32 v60, 0xbfb8aa3b, v60
    v_mul_f32 v61, 0xbfb8aa3b, v61
    v_cvt_pk_bf16_f32 v23, v60, v61
    v_lshlrev_b32 v60, 16, v24
    v_and_b32 v61, 0xffff0000, v24
    v_mul_f32 v60, 0xbfb8aa3b, v60
    v_mul_f32 v61, 0xbfb8aa3b, v61
    v_cvt_pk_bf16_f32 v24, v60, v61
    v_lshlrev_b32 v60, 16, v25
    v_and_b32 v61, 0xffff0000, v25
    v_mul_f32 v60, 0xbfb8aa3b, v60
    v_mul_f32 v61, 0xbfb8aa3b, v61
    v_cvt_pk_bf16_f32 v25, v60, v61
    v_lshlrev_b32 v60, 16, v26
    v_and_b32 v61, 0xffff0000, v26
    v_mul_f32 v60, 0xbfb8aa3b, v60
    v_mul_f32 v61, 0xbfb8aa3b, v61
    v_cvt_pk_bf16_f32 v26, v60, v61
    v_lshlrev_b32 v60, 16, v27
    v_and_b32 v61, 0xffff0000, v27
    v_mul_f32 v60, 0xbfb8aa3b, v60
    v_mul_f32 v61, 0xbfb8aa3b, v61
    v_cvt_pk_bf16_f32 v27, v60, v61
    v_lshlrev_b32 v60, 16, v28
    v_and_b32 v61, 0xffff0000, v28
    v_mul_f32 v60, 0xbfb8aa3b, v60
    v_mul_f32 v61, 0xbfb8aa3b, v61
    v_cvt_pk_bf16_f32 v28, v60, v61
    v_lshlrev_b32 v60, 16, v29
    v_and_b32 v61, 0xffff0000, v29
    v_mul_f32 v60, 0xbfb8aa3b, v60
    v_mul_f32 v61, 0xbfb8aa3b, v61
    v_cvt_pk_bf16_f32 v29, v60, v61
    v_lshlrev_b32 v60, 16, v30
    v_and_b32 v61, 0xffff0000, v30
    v_mul_f32 v60, 0xbfb8aa3b, v60
    v_mul_f32 v61, 0xbfb8aa3b, v61
    v_cvt_pk_bf16_f32 v30, v60, v61
    v_lshlrev_b32 v60, 16, v31
    v_and_b32 v61, 0xffff0000, v31
    v_mul_f32 v60, 0xbfb8aa3b, v60
    v_mul_f32 v61, 0xbfb8aa3b, v61
    v_cvt_pk_bf16_f32 v31, v60, v61
    v_lshlrev_b32 v60, 16, v32
    v_and_b32 v61, 0xffff0000, v32
    v_mul_f32 v60, 0xbfb8aa3b, v60
    v_mul_f32 v61, 0xbfb8aa3b, v61
    v_cvt_pk_bf16_f32 v32, v60, v61
    v_lshlrev_b32 v60, 16, v33
    v_and_b32 v61, 0xffff0000, v33
    v_mul_f32 v60, 0xbfb8aa3b, v60
    v_mul_f32 v61, 0xbfb8aa3b, v61
    v_cvt_pk_bf16_f32 v33, v60, v61
    v_lshlrev_b32 v60, 16, v34
    v_and_b32 v61, 0xffff0000, v34
    v_mul_f32 v60, 0xbfb8aa3b, v60
    v_mul_f32 v61, 0xbfb8aa3b, v61
    v_cvt_pk_bf16_f32 v34, v60, v61
    v_lshlrev_b32 v60, 16, v35
    v_and_b32 v61, 0xffff0000, v35
    v_mul_f32 v60, 0xbfb8aa3b, v60
    v_mul_f32 v61, 0xbfb8aa3b, v61
    v_cvt_pk_bf16_f32 v35, v60, v61
    v_lshlrev_b32 v60, 16, v36
    v_and_b32 v61, 0xffff0000, v36
    v_mul_f32 v60, 0xbfb8aa3b, v60
    v_mul_f32 v61, 0xbfb8aa3b, v61
    v_cvt_pk_bf16_f32 v36, v60, v61
    v_lshlrev_b32 v60, 16, v37
    v_and_b32 v61, 0xffff0000, v37
    v_mul_f32 v60, 0xbfb8aa3b, v60
    v_mul_f32 v61, 0xbfb8aa3b, v61
    v_cvt_pk_bf16_f32 v37, v60, v61
    v_lshlrev_b32 v60, 16, v38
    v_and_b32 v61, 0xffff0000, v38
    v_mul_f32 v60, 0xbfb8aa3b, v60
    v_mul_f32 v61, 0xbfb8aa3b, v61
    v_cvt_pk_bf16_f32 v38, v60, v61
    v_lshlrev_b32 v60, 16, v39
    v_and_b32 v61, 0xffff0000, v39
    v_mul_f32 v60, 0xbfb8aa3b, v60
    v_mul_f32 v61, 0xbfb8aa3b, v61
    v_cvt_pk_bf16_f32 v39, v60, v61
    v_lshlrev_b32 v60, 16, v40
    v_and_b32 v61, 0xffff0000, v40
    v_mul_f32 v60, 0xbfb8aa3b, v60
    v_mul_f32 v61, 0xbfb8aa3b, v61
    v_cvt_pk_bf16_f32 v40, v60, v61
    v_lshlrev_b32 v60, 16, v41
    v_and_b32 v61, 0xffff0000, v41
    v_mul_f32 v60, 0xbfb8aa3b, v60
    v_mul_f32 v61, 0xbfb8aa3b, v61
    v_cvt_pk_bf16_f32 v41, v60, v61
    v_lshlrev_b32 v60, 16, v42
    v_and_b32 v61, 0xffff0000, v42
    v_mul_f32 v60, 0xbfb8aa3b, v60
    v_mul_f32 v61, 0xbfb8aa3b, v61
    v_cvt_pk_bf16_f32 v42, v60, v61
    v_lshlrev_b32 v60, 16, v43
    v_and_b32 v61, 0xffff0000, v43
    v_mul_f32 v60, 0xbfb8aa3b, v60
    v_mul_f32 v61, 0xbfb8aa3b, v61
    v_cvt_pk_bf16_f32 v43, v60, v61
    v_lshlrev_b32 v60, 16, v44
    v_and_b32 v61, 0xffff0000, v44
    v_mul_f32 v60, 0xbfb8aa3b, v60
    v_mul_f32 v61, 0xbfb8aa3b, v61
    v_cvt_pk_bf16_f32 v44, v60, v61
    v_lshlrev_b32 v60, 16, v45
    v_and_b32 v61, 0xffff0000, v45
    v_mul_f32 v60, 0xbfb8aa3b, v60
    v_mul_f32 v61, 0xbfb8aa3b, v61
    v_cvt_pk_bf16_f32 v45, v60, v61
    v_lshlrev_b32 v60, 16, v46
    v_and_b32 v61, 0xffff0000, v46
    v_mul_f32 v60, 0xbfb8aa3b, v60
    v_mul_f32 v61, 0xbfb8aa3b, v61
    v_cvt_pk_bf16_f32 v46, v60, v61
    v_lshlrev_b32 v60, 16, v47
    v_and_b32 v61, 0xffff0000, v47
    v_mul_f32 v60, 0xbfb8aa3b, v60
    v_mul_f32 v61, 0xbfb8aa3b, v61
    v_cvt_pk_bf16_f32 v47, v60, v61
    v_perm_b32 v48, v20, v16, s40
    v_perm_b32 v49, v28, v24, s40
    v_perm_b32 v50, v36, v32, s40
    v_perm_b32 v51, v44, v40, s40
    buffer_store_dwordx4 v[48:51], v6, s[28:31], 0 offen offset:0
    v_perm_b32 v52, v20, v16, s41
    v_perm_b32 v53, v28, v24, s41
    v_perm_b32 v54, v36, v32, s41
    v_perm_b32 v55, v44, v40, s41
    buffer_store_dwordx4 v[52:55], v6, s[28:31], 0 offen offset:512
    v_perm_b32 v48, v21, v17, s40
    v_perm_b32 v49, v29, v25, s40
    v_perm_b32 v50, v37, v33, s40
    v_perm_b32 v51, v45, v41, s40
    buffer_store_dwordx4 v[48:51], v6, s[28:31], 0 offen offset:1024
    v_perm_b32 v52, v21, v17, s41
    v_perm_b32 v53, v29, v25, s41
    v_perm_b32 v54, v37, v33, s41
    v_perm_b32 v55, v45, v41, s41
    buffer_store_dwordx4 v[52:55], v6, s[28:31], 0 offen offset:1536
    v_perm_b32 v48, v22, v18, s40
    v_perm_b32 v49, v30, v26, s40
    v_perm_b32 v50, v38, v34, s40
    v_perm_b32 v51, v46, v42, s40
    buffer_store_dwordx4 v[48:51], v6, s[28:31], 0 offen offset:2048
    v_perm_b32 v52, v22, v18, s41
    v_perm_b32 v53, v30, v26, s41
    v_perm_b32 v54, v38, v34, s41
    v_perm_b32 v55, v46, v42, s41
    buffer_store_dwordx4 v[52:55], v6, s[28:31], 0 offen offset:2560
    v_perm_b32 v48, v23, v19, s40
    v_perm_b32 v49, v31, v27, s40
    v_perm_b32 v50, v39, v35, s40
    v_perm_b32 v51, v47, v43, s40
    buffer_store_dwordx4 v[48:51], v6, s[28:31], 0 offen offset:3072
    v_perm_b32 v52, v23, v19, s41
    v_perm_b32 v53, v31, v27, s41
    v_perm_b32 v54, v39, v35, s41
    v_perm_b32 v55, v47, v43, s41
    buffer_store_dwordx4 v[52:55], v6, s[28:31], 0 offen offset:3584
    s_endpgm
    s_nop 0
K1_OH:
    s_add_u32 s28, s18, 0x691000
    s_addc_u32 s29, s19, 0
    s_mov_b32 s30, 0x400
    s_mov_b32 s31, 0x00020000
    v_add_u32 v5, 0, v2
    v_lshrrev_b32 v6, 3, v5
    v_and_b32 v7, 7, v5
    v_lshrrev_b32 v8, 1, v6
    v_and_b32 v9, 1, v6
    v_lshlrev_b32 v9, 4, v9
    v_mov_b32 v10, 0x3f80
    v_lshlrev_b32 v10, v9, v10
    v_cmp_eq_u32 vcc, v8, v7
    s_nop 1
    v_cndmask_b32 v10, 0, v10, vcc
    v_lshlrev_b32 v5, 2, v5
    buffer_store_dword v10, v5, s[28:31], 0 offen
    v_add_u32 v5, 64, v2
    v_lshrrev_b32 v6, 3, v5
    v_and_b32 v7, 7, v5
    v_lshrrev_b32 v8, 1, v6
    v_and_b32 v9, 1, v6
    v_lshlrev_b32 v9, 4, v9
    v_mov_b32 v10, 0x3f80
    v_lshlrev_b32 v10, v9, v10
    v_cmp_eq_u32 vcc, v8, v7
    s_nop 1
    v_cndmask_b32 v10, 0, v10, vcc
    v_lshlrev_b32 v5, 2, v5
    buffer_store_dword v10, v5, s[28:31], 0 offen
    v_add_u32 v5, 128, v2
    v_lshrrev_b32 v6, 3, v5
    v_and_b32 v7, 7, v5
    v_lshrrev_b32 v8, 1, v6
    v_and_b32 v9, 1, v6
    v_lshlrev_b32 v9, 4, v9
    v_mov_b32 v10, 0x3f80
    v_lshlrev_b32 v10, v9, v10
    v_cmp_eq_u32 vcc, v8, v7
    s_nop 1
    v_cndmask_b32 v10, 0, v10, vcc
    v_lshlrev_b32 v5, 2, v5
    buffer_store_dword v10, v5, s[28:31], 0 offen
    s_nop 0
K1_END:
    s_endpgm
.globl standalone__edge_featured_mpnn_egc__graph_kernel
.p2align 8
.type standalone__edge_featured_mpnn_egc__graph_kernel,@function
standalone__edge_featured_mpnn_egc__graph_kernel:
    s_cmp_ge_u32 s2, 1000
    s_cbranch_scc1 K2_END
    s_setprio 3
    s_load_dwordx4 s[4:7], s[0:1], 0
    s_load_dwordx2 s[10:11], s[0:1], 56
    s_load_dwordx2 s[8:9], s[0:1], 72
    v_lshrrev_b32 v9, 6, v0
    v_and_b32 v10, 63, v0
    v_readfirstlane_b32 s3, v9
    v_lshrrev_b32 v9, 4, v10
    v_and_b32 v5, 15, v10
    s_and_b32 s55, s2, 7
    s_mul_i32 s55, s55, 125
    s_lshr_b32 s24, s2, 3
    s_bfe_u32 s25, s24, 0x10005
    s_xor_b32 s25, s24, s25
    s_cmp_lt_u32 s25, 125
    s_cselect_b32 s24, s25, s24
    s_add_u32 s55, s55, s24
    s_mul_i32 s56, s55, 25
    s_add_u32 s57, s56, 26
    s_add_u32 s56, s56, 1
    s_lshr_b32 s56, s56, 1
    s_lshr_b32 s57, s57, 1
    s_sub_u32 s57, s57, s56
    v_lshlrev_b32 v8, 4, v10
    v_lshlrev_b32 v1, 4, v5
    v_mov_b32 v11, 1
    v_mul_u32_u24 v12, 32896, v0
    s_lshl_b32 s58, s55, 5
    s_add_u32 s24, s58, 0xa00000
    s_mov_b32 s64, 0xbfb8aa3b
    s_mov_b32 s65, 0xbfb8aa3b
    s_mov_b32 s66, 1.0
    s_mov_b32 s67, 1.0
    s_waitcnt lgkmcnt(0)
    s_mov_b32 s12, s8
    s_mov_b32 s13, s9
    s_mov_b32 s14, 0x10000000
    s_mov_b32 s15, 0x00020000
    buffer_load_dwordx4 v[16:19], v12, s[12:15], s24 offen
    buffer_load_dwordx4 v[20:23], v12, s[12:15], s24 offen offset:16
    s_lshl_b32 s25, s55, 12
    s_add_u32 s25, s25, 0x1fffe00
    v_mov_b32 v12, 0x690000
    v_mov_b32 v13, s25
    v_cmp_gt_u32 vcc, 32, v10
    s_nop 1
    v_cndmask_b32 v12, v13, v12, vcc
    v_add_u32 v12, v8, v12
    s_lshl_b32 s26, s3, 10
    buffer_load_dwordx4 v[112:115], v12, s[12:15], s26 offen
    buffer_load_dwordx4 v[116:119], v12, s[12:15], s26 offen offset:512
    s_mov_b32 s16, s8
    s_mov_b32 s17, s9
    s_mov_b32 s18, 0x61a800
    s_mov_b32 s19, 0x00020000
    s_add_u32 s20, s8, 0x1c00000
    s_addc_u32 s21, s9, 0
    s_mov_b32 s22, 0x30d400
    s_mov_b32 s23, 0x00020000
    s_mov_b32 s59, 0
    v_lshlrev_b32 v2, 4, v9
    v_add_u32 v2, 8192, v2
    v_lshlrev_b32 v3, 3, v9
    v_add_u32 v3, 29888, v3
    v_mov_b32 v4, 15424
    v_mov_b32 v13, 22656
    v_cndmask_b32 v4, v13, v4, vcc
    v_lshl_add_u32 v4, v5, 2, v4
    s_add_u32 s26, s8, 0x690fe0
    s_addc_u32 s27, s9, 0
    v_mov_b32 v6, s6
    v_mov_b32 v7, s7
    v_mov_b32 v12, s26
    v_mov_b32 v13, s27
    v_cndmask_b32 v6, v12, v6, vcc
    v_cndmask_b32 v7, v13, v7, vcc
    v_lshlrev_b32 v12, 4, v9
    v_add_co_u32 v6, vcc, v6, v12
    s_nop 1
    v_addc_co_u32 v7, vcc, 0, v7, vcc
    v_mov_b32 v9, v0
    v_mul_u32_u24 v0, 1563, v0
    s_mov_b32 s54, 0
    s_mov_b32 s52, 0
    s_mov_b32 s53, 0
    s_waitcnt vmcnt(2)
    s_branch K2_FILL1
K2_FILL:
    v_mul_u32_u24 v12, 32896, v9
    s_add_u32 s24, s58, 0xa00000
    buffer_load_dwordx4 v[16:19], v12, s[12:15], s24 offen
    buffer_load_dwordx4 v[20:23], v12, s[12:15], s24 offen offset:16
    s_waitcnt vmcnt(0)
K2_FILL1:
    v_cmp_lt_u32 vcc, 7, v16
    s_and_saveexec_b64 s[36:37], vcc
    s_nop 3
    s_cbranch_execz K2_NOSEC
    v_mul_u32_u24 v12, 32896, v9
    s_add_u32 s24, s58, 0x1280000
    buffer_load_dwordx4 v[24:27], v12, s[12:15], s24 offen
    buffer_load_dwordx4 v[28:31], v12, s[12:15], s24 offen offset:16
    s_waitcnt vmcnt(0)
K2_NOSEC:
    s_mov_b64 exec, s[36:37]
    v_cmp_lt_u32 vcc, 15, v16
    s_cmp_lg_u64 vcc, 0
    s_cselect_b32 s34, 1, 0
    v_mov_b32 v12, s34
    s_lshl_b32 s26, s3, 2
    v_mov_b32 v13, s26
    ds_write_b32 v13, v12 offset:33536
    v_mov_b32 v32, 0
    v_mov_b32 v33, 0
    v_mov_b32 v37, 0
    v_mov_b32 v36, 1
    v_cmp_lt_u32 vcc, 0, v16
    s_and_b64 exec, exec, vcc
    v_lshrrev_b32 v14, 8, v17
    v_and_b32 v14, 48, v14
    v_lshlrev_b64 v[34:35], v14, v[36:37]
    v_add_u32 v32, v32, v34
    v_add_u32 v33, v33, v35
    v_cmp_lt_u32 vcc, 1, v16
    s_and_b64 exec, exec, vcc
    s_nop 3
    s_cbranch_execz K2_COUNTED
    v_lshrrev_b32 v14, 8, v18
    v_and_b32 v14, 48, v14
    v_lshlrev_b64 v[34:35], v14, v[36:37]
    v_add_u32 v32, v32, v34
    v_add_u32 v33, v33, v35
    v_cmp_lt_u32 vcc, 2, v16
    s_and_b64 exec, exec, vcc
    s_nop 3
    s_cbranch_execz K2_COUNTED
    v_lshrrev_b32 v14, 8, v19
    v_and_b32 v14, 48, v14
    v_lshlrev_b64 v[34:35], v14, v[36:37]
    v_add_u32 v32, v32, v34
    v_add_u32 v33, v33, v35
    v_cmp_lt_u32 vcc, 3, v16
    s_and_b64 exec, exec, vcc
    s_nop 3
    s_cbranch_execz K2_COUNTED
    v_lshrrev_b32 v14, 8, v20
    v_and_b32 v14, 48, v14
    v_lshlrev_b64 v[34:35], v14, v[36:37]
    v_add_u32 v32, v32, v34
    v_add_u32 v33, v33, v35
    v_cmp_lt_u32 vcc, 4, v16
    s_and_b64 exec, exec, vcc
    s_nop 3
    s_cbranch_execz K2_COUNTED
    v_lshrrev_b32 v14, 8, v21
    v_and_b32 v14, 48, v14
    v_lshlrev_b64 v[34:35], v14, v[36:37]
    v_add_u32 v32, v32, v34
    v_add_u32 v33, v33, v35
    v_cmp_lt_u32 vcc, 5, v16
    s_and_b64 exec, exec, vcc
    s_nop 3
    s_cbranch_execz K2_COUNTED
    v_lshrrev_b32 v14, 8, v22
    v_and_b32 v14, 48, v14
    v_lshlrev_b64 v[34:35], v14, v[36:37]
    v_add_u32 v32, v32, v34
    v_add_u32 v33, v33, v35
    v_cmp_lt_u32 vcc, 6, v16
    s_and_b64 exec, exec, vcc
    s_nop 3
    s_cbranch_execz K2_COUNTED
    v_lshrrev_b32 v14, 8, v23
    v_and_b32 v14, 48, v14
    v_lshlrev_b64 v[34:35], v14, v[36:37]
    v_add_u32 v32, v32, v34
    v_add_u32 v33, v33, v35
    s_nop 1
    s_branch K2_COUNT_X
K2_COUNTED:
    s_mov_b64 exec, s[36:37]
    v_mov_b32 v80, v32
    v_mov_b32 v81, v33
    s_nop 0
    v_add_u32_dpp v80, v80, v80 row_shr:1 row_mask:0xf bank_mask:0xf bound_ctrl:0
    v_add_u32_dpp v81, v81, v81 row_shr:1 row_mask:0xf bank_mask:0xf bound_ctrl:0
    s_nop 0
    v_add_u32_dpp v80, v80, v80 row_shr:2 row_mask:0xf bank_mask:0xf bound_ctrl:0
    v_add_u32_dpp v81, v81, v81 row_shr:2 row_mask:0xf bank_mask:0xf bound_ctrl:0
    s_nop 0
    v_add_u32_dpp v80, v80, v80 row_shr:4 row_mask:0xf bank_mask:0xf bound_ctrl:0
    v_add_u32_dpp v81, v81, v81 row_shr:4 row_mask:0xf bank_mask:0xf bound_ctrl:0
    s_nop 0
    v_add_u32_dpp v80, v80, v80 row_shr:8 row_mask:0xf bank_mask:0xf bound_ctrl:0
    v_add_u32_dpp v81, v81, v81 row_shr:8 row_mask:0xf bank_mask:0xf bound_ctrl:0
    s_nop 0
    v_add_u32_dpp v80, v80, v80 row_bcast:15 row_mask:0xa bank_mask:0xf
    v_add_u32_dpp v81, v81, v81 row_bcast:15 row_mask:0xa bank_mask:0xf
    s_nop 0
    v_add_u32_dpp v80, v80, v80 row_bcast:31 row_mask:0xc bank_mask:0xf
    v_add_u32_dpp v81, v81, v81 row_bcast:31 row_mask:0xc bank_mask:0xf
    v_readlane_b32 s28, v80, 63
    v_readlane_b32 s29, v81, 63
    v_sub_u32 v32, v80, v32
    v_sub_u32 v33, v81, v33
    s_lshl_b32 s30, s3, 3
    v_mov_b32 v80, s28
    v_mov_b32 v81, s29
    v_mov_b32 v82, s30
    ds_write_b64 v82, v[80:81] offset:33504
    s_waitcnt lgkmcnt(0)
    s_barrier
    v_mov_b32 v82, 0
    ds_read_b128 v[84:87], v82 offset:33504
    ds_read_b128 v[88:91], v82 offset:33520
    s_waitcnt lgkmcnt(0)
    v_readfirstlane_b32 s44, v84
    v_readfirstlane_b32 s45, v85
    v_readfirstlane_b32 s46, v86
    v_readfirstlane_b32 s47, v87
    v_readfirstlane_b32 s48, v88
    v_readfirstlane_b32 s49, v89
    v_readfirstlane_b32 s50, v90
    v_readfirstlane_b32 s51, v91
    s_add_u32 s40, s44, s46
    s_add_u32 s40, s40, s48
    s_add_u32 s40, s40, s50
    s_add_u32 s41, s45, s47
    s_add_u32 s41, s41, s49
    s_add_u32 s41, s41, s51
    s_cmp_gt_u32 s3, 0
    s_cselect_b32 s44, s44, 0
    s_cselect_b32 s45, s45, 0
    s_cmp_gt_u32 s3, 1
    s_cselect_b32 s46, s46, 0
    s_cselect_b32 s47, s47, 0
    s_cmp_gt_u32 s3, 2
    s_cselect_b32 s48, s48, 0
    s_cselect_b32 s49, s49, 0
    s_add_u32 s44, s44, s46
    s_add_u32 s44, s44, s48
    s_add_u32 s45, s45, s47
    s_add_u32 s45, s45, s49
    v_mov_b32 v82, 0
    ds_read_b128 v[84:87], v82 offset:33536
    s_and_b32 s46, s40, 0xffff
    s_lshr_b32 s47, s40, 16
    s_and_b32 s48, s41, 0xffff
    s_lshr_b32 s49, s41, 16
    s_add_u32 s50, s46, s47
    s_add_u32 s51, s50, s48
    s_add_u32 s31, s51, s49
    s_lshl_b32 s46, s46, 16
    s_add_u32 s44, s44, s46
    s_lshl_b32 s51, s51, 16
    s_add_u32 s50, s50, s51
    s_add_u32 s45, s45, s50
    v_add_u32 v32, s44, v32
    v_add_u32 v33, s45, v33
    s_sub_u32 s32, s31, s54
    s_min_u32 s32, s32, 1792
    v_cmp_lt_u32 vcc, 0, v16
    s_and_b64 exec, exec, vcc
    v_lshrrev_b32 v14, 8, v17
    v_and_b32 v14, 48, v14
    v_lshrrev_b64 v[34:35], v14, v[32:33]
    v_and_b32 v34, 0xffff, v34
    v_subrev_u32 v34, s54, v34
    v_lshlrev_b64 v[38:39], v14, v[36:37]
    v_add_u32 v32, v32, v38
    v_add_u32 v33, v33, v39
    v_cmp_gt_u32 vcc, s32, v34
    s_and_saveexec_b64 s[26:27], vcc
    v_and_b32 v40, 0x3fff, v17
    v_lshlrev_b32 v40, 9, v40
    v_bfe_u32 v41, v17, 14, 4
    v_lshrrev_b32 v42, 18, v17
    v_add_lshl_u32 v42, v42, v0, 5
    v_lshlrev_b32 v43, 2, v34
    ds_write_b32 v43, v40 offset:8192
    ds_write_b32 v43, v42 offset:15424
    v_lshlrev_b32 v44, 5, v41
    ds_write_b32 v43, v44 offset:22656
    v_lshlrev_b32 v41, v41, v11
    v_lshlrev_b32 v43, 1, v34
    ds_write_b16 v43, v41 offset:29888
    s_mov_b64 exec, s[26:27]
    v_cmp_lt_u32 vcc, 1, v16
    s_and_b64 exec, exec, vcc
    s_nop 3
    s_cbranch_execz K2_FILLED
    v_lshrrev_b32 v14, 8, v18
    v_and_b32 v14, 48, v14
    v_lshrrev_b64 v[34:35], v14, v[32:33]
    v_and_b32 v34, 0xffff, v34
    v_subrev_u32 v34, s54, v34
    v_lshlrev_b64 v[38:39], v14, v[36:37]
    v_add_u32 v32, v32, v38
    v_add_u32 v33, v33, v39
    v_cmp_gt_u32 vcc, s32, v34
    s_and_saveexec_b64 s[26:27], vcc
    v_and_b32 v40, 0x3fff, v18
    v_lshlrev_b32 v40, 9, v40
    v_bfe_u32 v41, v18, 14, 4
    v_lshrrev_b32 v42, 18, v18
    v_add_lshl_u32 v42, v42, v0, 5
    v_lshlrev_b32 v43, 2, v34
    ds_write_b32 v43, v40 offset:8192
    ds_write_b32 v43, v42 offset:15424
    v_lshlrev_b32 v44, 5, v41
    ds_write_b32 v43, v44 offset:22656
    v_lshlrev_b32 v41, v41, v11
    v_lshlrev_b32 v43, 1, v34
    ds_write_b16 v43, v41 offset:29888
    s_mov_b64 exec, s[26:27]
    v_cmp_lt_u32 vcc, 2, v16
    s_and_b64 exec, exec, vcc
    s_nop 3
    s_cbranch_execz K2_FILLED
    v_lshrrev_b32 v14, 8, v19
    v_and_b32 v14, 48, v14
    v_lshrrev_b64 v[34:35], v14, v[32:33]
    v_and_b32 v34, 0xffff, v34
    v_subrev_u32 v34, s54, v34
    v_lshlrev_b64 v[38:39], v14, v[36:37]
    v_add_u32 v32, v32, v38
    v_add_u32 v33, v33, v39
    v_cmp_gt_u32 vcc, s32, v34
    s_and_saveexec_b64 s[26:27], vcc
    v_and_b32 v40, 0x3fff, v19
    v_lshlrev_b32 v40, 9, v40
    v_bfe_u32 v41, v19, 14, 4
    v_lshrrev_b32 v42, 18, v19
    v_add_lshl_u32 v42, v42, v0, 5
    v_lshlrev_b32 v43, 2, v34
    ds_write_b32 v43, v40 offset:8192
    ds_write_b32 v43, v42 offset:15424
    v_lshlrev_b32 v44, 5, v41
    ds_write_b32 v43, v44 offset:22656
    v_lshlrev_b32 v41, v41, v11
    v_lshlrev_b32 v43, 1, v34
    ds_write_b16 v43, v41 offset:29888
    s_mov_b64 exec, s[26:27]
    v_cmp_lt_u32 vcc, 3, v16
    s_and_b64 exec, exec, vcc
    s_nop 3
    s_cbranch_execz K2_FILLED
    v_lshrrev_b32 v14, 8, v20
    v_and_b32 v14, 48, v14
    v_lshrrev_b64 v[34:35], v14, v[32:33]
    v_and_b32 v34, 0xffff, v34
    v_subrev_u32 v34, s54, v34
    v_lshlrev_b64 v[38:39], v14, v[36:37]
    v_add_u32 v32, v32, v38
    v_add_u32 v33, v33, v39
    v_cmp_gt_u32 vcc, s32, v34
    s_and_saveexec_b64 s[26:27], vcc
    v_and_b32 v40, 0x3fff, v20
    v_lshlrev_b32 v40, 9, v40
    v_bfe_u32 v41, v20, 14, 4
    v_lshrrev_b32 v42, 18, v20
    v_add_lshl_u32 v42, v42, v0, 5
    v_lshlrev_b32 v43, 2, v34
    ds_write_b32 v43, v40 offset:8192
    ds_write_b32 v43, v42 offset:15424
    v_lshlrev_b32 v44, 5, v41
    ds_write_b32 v43, v44 offset:22656
    v_lshlrev_b32 v41, v41, v11
    v_lshlrev_b32 v43, 1, v34
    ds_write_b16 v43, v41 offset:29888
    s_mov_b64 exec, s[26:27]
    v_cmp_lt_u32 vcc, 4, v16
    s_and_b64 exec, exec, vcc
    s_nop 3
    s_cbranch_execz K2_FILLED
    v_lshrrev_b32 v14, 8, v21
    v_and_b32 v14, 48, v14
    v_lshrrev_b64 v[34:35], v14, v[32:33]
    v_and_b32 v34, 0xffff, v34
    v_subrev_u32 v34, s54, v34
    v_lshlrev_b64 v[38:39], v14, v[36:37]
    v_add_u32 v32, v32, v38
    v_add_u32 v33, v33, v39
    v_cmp_gt_u32 vcc, s32, v34
    s_and_saveexec_b64 s[26:27], vcc
    v_and_b32 v40, 0x3fff, v21
    v_lshlrev_b32 v40, 9, v40
    v_bfe_u32 v41, v21, 14, 4
    v_lshrrev_b32 v42, 18, v21
    v_add_lshl_u32 v42, v42, v0, 5
    v_lshlrev_b32 v43, 2, v34
    ds_write_b32 v43, v40 offset:8192
    ds_write_b32 v43, v42 offset:15424
    v_lshlrev_b32 v44, 5, v41
    ds_write_b32 v43, v44 offset:22656
    v_lshlrev_b32 v41, v41, v11
    v_lshlrev_b32 v43, 1, v34
    ds_write_b16 v43, v41 offset:29888
    s_mov_b64 exec, s[26:27]
    v_cmp_lt_u32 vcc, 5, v16
    s_and_b64 exec, exec, vcc
    s_nop 3
    s_cbranch_execz K2_FILLED
    v_lshrrev_b32 v14, 8, v22
    v_and_b32 v14, 48, v14
    v_lshrrev_b64 v[34:35], v14, v[32:33]
    v_and_b32 v34, 0xffff, v34
    v_subrev_u32 v34, s54, v34
    v_lshlrev_b64 v[38:39], v14, v[36:37]
    v_add_u32 v32, v32, v38
    v_add_u32 v33, v33, v39
    v_cmp_gt_u32 vcc, s32, v34
    s_and_saveexec_b64 s[26:27], vcc
    v_and_b32 v40, 0x3fff, v22
    v_lshlrev_b32 v40, 9, v40
    v_bfe_u32 v41, v22, 14, 4
    v_lshrrev_b32 v42, 18, v22
    v_add_lshl_u32 v42, v42, v0, 5
    v_lshlrev_b32 v43, 2, v34
    ds_write_b32 v43, v40 offset:8192
    ds_write_b32 v43, v42 offset:15424
    v_lshlrev_b32 v44, 5, v41
    ds_write_b32 v43, v44 offset:22656
    v_lshlrev_b32 v41, v41, v11
    v_lshlrev_b32 v43, 1, v34
    ds_write_b16 v43, v41 offset:29888
    s_mov_b64 exec, s[26:27]
    v_cmp_lt_u32 vcc, 6, v16
    s_and_b64 exec, exec, vcc
    s_nop 3
    s_cbranch_execz K2_FILLED
    v_lshrrev_b32 v14, 8, v23
    v_and_b32 v14, 48, v14
    v_lshrrev_b64 v[34:35], v14, v[32:33]
    v_and_b32 v34, 0xffff, v34
    v_subrev_u32 v34, s54, v34
    v_lshlrev_b64 v[38:39], v14, v[36:37]
    v_add_u32 v32, v32, v38
    v_add_u32 v33, v33, v39
    v_cmp_gt_u32 vcc, s32, v34
    s_and_saveexec_b64 s[26:27], vcc
    v_and_b32 v40, 0x3fff, v23
    v_lshlrev_b32 v40, 9, v40
    v_bfe_u32 v41, v23, 14, 4
    v_lshrrev_b32 v42, 18, v23
    v_add_lshl_u32 v42, v42, v0, 5
    v_lshlrev_b32 v43, 2, v34
    ds_write_b32 v43, v40 offset:8192
    ds_write_b32 v43, v42 offset:15424
    v_lshlrev_b32 v44, 5, v41
    ds_write_b32 v43, v44 offset:22656
    v_lshlrev_b32 v41, v41, v11
    v_lshlrev_b32 v43, 1, v34
    ds_write_b16 v43, v41 offset:29888
    s_mov_b64 exec, s[26:27]
    s_branch K2_FILL_X
K2_FILLED:
    s_mov_b64 exec, s[36:37]
    s_waitcnt lgkmcnt(0)
    v_or3_b32 v84, v84, v85, v86
    v_or_b32 v84, v84, v87
    s_nop 0
    v_readfirstlane_b32 s33, v84
    s_cmp_lg_u32 s54, 0
    s_nop 3
    s_cbranch_scc1 K2_PROC
    s_lshl_b32 s26, s3, 11
    v_add_u32 v14, s26, v8
    s_waitcnt vmcnt(0)
    ds_write_b128 v14, v[112:115]
    ds_write_b128 v14, v[116:119] offset:1024
    s_waitcnt lgkmcnt(0)
    v_mov_b32 v96, 0
    v_mov_b32 v97, 0
    v_mov_b32 v98, 0
    v_mov_b32 v99, 0
    v_mov_b32 v100, 0
    v_mov_b32 v101, 0
    v_mov_b32 v102, 0
    v_mov_b32 v103, 0
    v_mov_b32 v104, 0
    v_mov_b32 v105, 0
    v_mov_b32 v106, 0
    v_mov_b32 v107, 0
    v_mov_b32 v108, 0
    v_mov_b32 v109, 0
    v_mov_b32 v110, 0
    v_mov_b32 v111, 0
    v_mov_b32 v112, 0
    v_mov_b32 v113, 0
    v_mov_b32 v114, 0
    v_mov_b32 v115, 0
    v_mov_b32 v116, 0
    v_mov_b32 v117, 0
    v_mov_b32 v118, 0
    v_mov_b32 v119, 0
    v_mov_b32 v120, 0
    v_mov_b32 v121, 0
    v_mov_b32 v122, 0
    v_mov_b32 v123, 0
    v_mov_b32 v124, 0
    v_mov_b32 v125, 0
    v_mov_b32 v126, 0
    v_mov_b32 v127, 0
    s_nop 1
K2_PROC:
    s_add_u32 s38, s32, 15
    s_and_b32 s38, s38, 0xfffffff0
    v_lshrrev_b32 v16, 4, v8
    v_add_u32 v16, s32, v16
    v_cmp_gt_u32 vcc, s38, v16
    s_and_saveexec_b64 s[36:37], vcc
    s_nop 3
    s_cbranch_execz K2_PAD_DONE
    v_lshlrev_b32 v17, 2, v16
    v_mov_b32 v18, 0
    v_mov_b32 v19, 512
    ds_write_b32 v17, v18 offset:8192
    ds_write_b32 v17, v18 offset:15424
    ds_write_b32 v17, v19 offset:22656
    v_lshlrev_b32 v17, 1, v16
    ds_write_b16 v17, v18 offset:29888
    s_nop 0
K2_PAD_DONE:
    s_mov_b64 exec, s[36:37]
    s_waitcnt lgkmcnt(0)
    s_barrier
    s_lshr_b32 s38, s38, 4
    s_add_u32 s39, s3, s2
    s_and_b32 s39, s39, 3
    s_cmp_ge_u32 s39, s38
    s_cbranch_scc1 K2_TILES_DONE
    s_lshl_b32 s40, s39, 6
    v_add_u32 v10, s40, v2
    ds_read_b128 v[12:15], v10
    v_add_u32 v10, s40, v4
    ds_read_b32 v10, v10
    s_waitcnt lgkmcnt(0)
    v_add_u32 v12, v12, v1
    buffer_load_dwordx4 v[16:19], v12, s[16:19], 0 offen
    v_add_u32 v13, v13, v1
    buffer_load_dwordx4 v[20:23], v13, s[16:19], 0 offen
    v_add_u32 v14, v14, v1
    buffer_load_dwordx4 v[24:27], v14, s[16:19], 0 offen
    v_add_u32 v15, v15, v1
    buffer_load_dwordx4 v[28:31], v15, s[16:19], 0 offen
    v_add_co_u32 v94, vcc, v6, v10
    s_nop 1
    v_addc_co_u32 v95, vcc, 0, v7, vcc
    global_load_dwordx4 v[88:91], v[94:95], off
    buffer_load_dwordx4 v[32:35], v12, s[16:19], 0 offen offset:256
    buffer_load_dwordx4 v[36:39], v13, s[16:19], 0 offen offset:256
    buffer_load_dwordx4 v[40:43], v14, s[16:19], 0 offen offset:256
    buffer_load_dwordx4 v[44:47], v15, s[16:19], 0 offen offset:256
K2_TILE:
    s_sub_u32 s40, s38, s39
    s_cmp_ge_u32 s40, 21
    s_cbranch_scc1 K2_PR_DONE
    s_setprio 2
    s_cmp_ge_u32 s40, 13
    s_cbranch_scc1 K2_PR_DONE
    s_setprio 1
    s_cmp_ge_u32 s40, 5
    s_cbranch_scc1 K2_PR_DONE
    s_setprio 0
K2_PR_DONE:
    s_add_u32 s42, s39, 4
    s_cmp_lt_u32 s42, s38
    s_cbranch_scc0 K2_LAST
    s_lshl_b32 s41, s39, 5
    v_add_u32 v92, s41, v3
    ds_read_b64 v[92:93], v92
    ds_read_b128 v[80:83], v8
    ds_read_b128 v[84:87], v8 offset:1024
    s_lshl_b32 s40, s42, 6
    v_add_u32 v10, s40, v2
    ds_read_b128 v[12:15], v10
    v_add_u32 v10, s40, v4
    ds_read_b32 v10, v10
    s_waitcnt vmcnt(8)
    v_lshlrev_b32 v48, 16, v16
    v_and_b32 v52, 0xffff0000, v16
    v_lshlrev_b32 v56, 16, v17
    v_and_b32 v60, 0xffff0000, v17
    v_lshlrev_b32 v64, 16, v18
    v_and_b32 v68, 0xffff0000, v18
    v_lshlrev_b32 v72, 16, v19
    v_and_b32 v76, 0xffff0000, v19
    s_waitcnt vmcnt(7)
    v_lshlrev_b32 v49, 16, v20
    v_and_b32 v53, 0xffff0000, v20
    v_lshlrev_b32 v57, 16, v21
    v_and_b32 v61, 0xffff0000, v21
    v_lshlrev_b32 v65, 16, v22
    v_and_b32 v69, 0xffff0000, v22
    v_lshlrev_b32 v73, 16, v23
    v_and_b32 v77, 0xffff0000, v23
    s_waitcnt vmcnt(6)
    v_lshlrev_b32 v50, 16, v24
    v_and_b32 v54, 0xffff0000, v24
    v_lshlrev_b32 v58, 16, v25
    v_and_b32 v62, 0xffff0000, v25
    v_lshlrev_b32 v66, 16, v26
    v_and_b32 v70, 0xffff0000, v26
    v_lshlrev_b32 v74, 16, v27
    v_and_b32 v78, 0xffff0000, v27
    s_waitcnt vmcnt(5)
    v_lshlrev_b32 v51, 16, v28
    v_and_b32 v55, 0xffff0000, v28
    v_lshlrev_b32 v59, 16, v29
    v_and_b32 v63, 0xffff0000, v29
    v_lshlrev_b32 v67, 16, v30
    v_and_b32 v71, 0xffff0000, v30
    v_lshlrev_b32 v75, 16, v31
    v_and_b32 v79, 0xffff0000, v31
    s_waitcnt vmcnt(4)
    s_waitcnt lgkmcnt(3)
    v_mfma_f32_16x16x32_bf16 v[48:51], v[88:91], v[80:83], v[48:51]
    ds_read_b128 v[80:83], v8 offset:2048
    s_waitcnt lgkmcnt(1)
    v_mfma_f32_16x16x32_bf16 v[52:55], v[88:91], v[84:87], v[52:55]
    ds_read_b128 v[84:87], v8 offset:3072
    s_waitcnt lgkmcnt(1)
    v_mfma_f32_16x16x32_bf16 v[56:59], v[88:91], v[80:83], v[56:59]
    ds_read_b128 v[80:83], v8 offset:4096
    s_waitcnt lgkmcnt(1)
    v_mfma_f32_16x16x32_bf16 v[60:63], v[88:91], v[84:87], v[60:63]
    ds_read_b128 v[84:87], v8 offset:5120
    s_waitcnt lgkmcnt(1)
    v_mfma_f32_16x16x32_bf16 v[64:67], v[88:91], v[80:83], v[64:67]
    ds_read_b128 v[80:83], v8 offset:6144
    s_waitcnt lgkmcnt(1)
    v_mfma_f32_16x16x32_bf16 v[68:71], v[88:91], v[84:87], v[68:71]
    ds_read_b128 v[84:87], v8 offset:7168
    s_waitcnt lgkmcnt(1)
    v_mfma_f32_16x16x32_bf16 v[72:75], v[88:91], v[80:83], v[72:75]
    s_waitcnt lgkmcnt(0)
    v_mfma_f32_16x16x32_bf16 v[76:79], v[88:91], v[84:87], v[76:79]
    v_add_u32 v12, v12, v1
    buffer_load_dwordx4 v[16:19], v12, s[16:19], 0 offen
    v_add_u32 v13, v13, v1
    buffer_load_dwordx4 v[20:23], v13, s[16:19], 0 offen
    v_add_u32 v14, v14, v1
    buffer_load_dwordx4 v[24:27], v14, s[16:19], 0 offen
    v_add_u32 v15, v15, v1
    buffer_load_dwordx4 v[28:31], v15, s[16:19], 0 offen
    v_add_co_u32 v94, vcc, v6, v10
    s_nop 1
    v_addc_co_u32 v95, vcc, 0, v7, vcc
    global_load_dwordx4 v[88:91], v[94:95], off
    v_lshrrev_b32 v92, v5, v92
    v_and_b32 v92, 0x10001, v92
    v_mul_u32_u24 v92, 0x3f80, v92
    v_lshrrev_b32 v93, v5, v93
    v_and_b32 v93, 0x10001, v93
    v_mul_u32_u24 v93, 0x3f80, v93
    s_waitcnt vmcnt(7)
    v_exp_f32 v48, v48
    v_exp_f32 v49, v49
    v_exp_f32 v52, v52
    v_exp_f32 v53, v53
    v_exp_f32 v56, v56
    v_exp_f32 v57, v57
    v_exp_f32 v60, v60
    v_exp_f32 v61, v61
    v_pk_add_f32 v[48:49], v[48:49], s[66:67]
    v_pk_add_f32 v[52:53], v[52:53], s[66:67]
    v_pk_add_f32 v[56:57], v[56:57], s[66:67]
    v_pk_add_f32 v[60:61], v[60:61], s[66:67]
    v_rcp_f32 v48, v48
    v_rcp_f32 v49, v49
    v_rcp_f32 v52, v52
    v_rcp_f32 v53, v53
    v_rcp_f32 v56, v56
    v_rcp_f32 v57, v57
    v_rcp_f32 v60, v60
    v_rcp_f32 v61, v61
    v_lshlrev_b32 v80, 16, v32
    v_lshlrev_b32 v81, 16, v36
    v_and_b32 v82, 0xffff0000, v32
    v_and_b32 v83, 0xffff0000, v36
    v_lshlrev_b32 v84, 16, v33
    v_lshlrev_b32 v85, 16, v37
    v_and_b32 v86, 0xffff0000, v33
    v_and_b32 v87, 0xffff0000, v37
    v_pk_mul_f32 v[48:49], v[48:49], v[80:81]
    v_pk_mul_f32 v[52:53], v[52:53], v[82:83]
    v_pk_mul_f32 v[56:57], v[56:57], v[84:85]
    v_pk_mul_f32 v[60:61], v[60:61], v[86:87]
    v_cvt_pk_bf16_f32 v48, v48, v49
    v_cvt_pk_bf16_f32 v52, v52, v53
    v_cvt_pk_bf16_f32 v56, v56, v57
    v_cvt_pk_bf16_f32 v60, v60, v61
    v_exp_f32 v64, v64
    v_exp_f32 v65, v65
    v_exp_f32 v68, v68
    v_exp_f32 v69, v69
    v_exp_f32 v72, v72
    v_exp_f32 v73, v73
    v_exp_f32 v76, v76
    v_exp_f32 v77, v77
    v_pk_add_f32 v[64:65], v[64:65], s[66:67]
    v_pk_add_f32 v[68:69], v[68:69], s[66:67]
    v_pk_add_f32 v[72:73], v[72:73], s[66:67]
    v_pk_add_f32 v[76:77], v[76:77], s[66:67]
    v_rcp_f32 v64, v64
    v_rcp_f32 v65, v65
    v_rcp_f32 v68, v68
    v_rcp_f32 v69, v69
    v_rcp_f32 v72, v72
    v_rcp_f32 v73, v73
    v_rcp_f32 v76, v76
    v_rcp_f32 v77, v77
    v_lshlrev_b32 v80, 16, v34
    v_lshlrev_b32 v81, 16, v38
    v_and_b32 v82, 0xffff0000, v34
    v_and_b32 v83, 0xffff0000, v38
    v_lshlrev_b32 v84, 16, v35
    v_lshlrev_b32 v85, 16, v39
    v_and_b32 v86, 0xffff0000, v35
    v_and_b32 v87, 0xffff0000, v39
    buffer_load_dwordx4 v[32:35], v12, s[16:19], 0 offen offset:256
    buffer_load_dwordx4 v[36:39], v13, s[16:19], 0 offen offset:256
    v_pk_mul_f32 v[64:65], v[64:65], v[80:81]
    v_pk_mul_f32 v[68:69], v[68:69], v[82:83]
    v_pk_mul_f32 v[72:73], v[72:73], v[84:85]
    v_pk_mul_f32 v[76:77], v[76:77], v[86:87]
    v_cvt_pk_bf16_f32 v64, v64, v65
    v_cvt_pk_bf16_f32 v68, v68, v69
    v_cvt_pk_bf16_f32 v72, v72, v73
    v_cvt_pk_bf16_f32 v76, v76, v77
    s_waitcnt vmcnt(7)
    v_exp_f32 v50, v50
    v_exp_f32 v51, v51
    v_exp_f32 v54, v54
    v_exp_f32 v55, v55
    v_exp_f32 v58, v58
    v_exp_f32 v59, v59
    v_exp_f32 v62, v62
    v_exp_f32 v63, v63
    v_pk_add_f32 v[50:51], v[50:51], s[66:67]
    v_pk_add_f32 v[54:55], v[54:55], s[66:67]
    v_pk_add_f32 v[58:59], v[58:59], s[66:67]
    v_pk_add_f32 v[62:63], v[62:63], s[66:67]
    v_rcp_f32 v50, v50
    v_rcp_f32 v51, v51
    v_rcp_f32 v54, v54
    v_rcp_f32 v55, v55
    v_rcp_f32 v58, v58
    v_rcp_f32 v59, v59
    v_rcp_f32 v62, v62
    v_rcp_f32 v63, v63
    v_lshlrev_b32 v80, 16, v40
    v_lshlrev_b32 v81, 16, v44
    v_and_b32 v82, 0xffff0000, v40
    v_and_b32 v83, 0xffff0000, v44
    v_lshlrev_b32 v84, 16, v41
    v_lshlrev_b32 v85, 16, v45
    v_and_b32 v86, 0xffff0000, v41
    v_and_b32 v87, 0xffff0000, v45
    v_pk_mul_f32 v[50:51], v[50:51], v[80:81]
    v_pk_mul_f32 v[54:55], v[54:55], v[82:83]
    v_pk_mul_f32 v[58:59], v[58:59], v[84:85]
    v_pk_mul_f32 v[62:63], v[62:63], v[86:87]
    v_cvt_pk_bf16_f32 v49, v50, v51
    v_cvt_pk_bf16_f32 v53, v54, v55
    v_cvt_pk_bf16_f32 v57, v58, v59
    v_cvt_pk_bf16_f32 v61, v62, v63
    v_exp_f32 v66, v66
    v_exp_f32 v67, v67
    v_exp_f32 v70, v70
    v_exp_f32 v71, v71
    v_exp_f32 v74, v74
    v_exp_f32 v75, v75
    v_exp_f32 v78, v78
    v_exp_f32 v79, v79
    v_pk_add_f32 v[66:67], v[66:67], s[66:67]
    v_pk_add_f32 v[70:71], v[70:71], s[66:67]
    v_pk_add_f32 v[74:75], v[74:75], s[66:67]
    v_pk_add_f32 v[78:79], v[78:79], s[66:67]
    v_rcp_f32 v66, v66
    v_rcp_f32 v67, v67
    v_rcp_f32 v70, v70
    v_rcp_f32 v71, v71
    v_rcp_f32 v74, v74
    v_rcp_f32 v75, v75
    v_rcp_f32 v78, v78
    v_rcp_f32 v79, v79
    v_lshlrev_b32 v80, 16, v42
    v_lshlrev_b32 v81, 16, v46
    v_and_b32 v82, 0xffff0000, v42
    v_and_b32 v83, 0xffff0000, v46
    v_lshlrev_b32 v84, 16, v43
    v_lshlrev_b32 v85, 16, v47
    v_and_b32 v86, 0xffff0000, v43
    v_and_b32 v87, 0xffff0000, v47
    buffer_load_dwordx4 v[40:43], v14, s[16:19], 0 offen offset:256
    buffer_load_dwordx4 v[44:47], v15, s[16:19], 0 offen offset:256
    v_pk_mul_f32 v[66:67], v[66:67], v[80:81]
    v_pk_mul_f32 v[70:71], v[70:71], v[82:83]
    v_pk_mul_f32 v[74:75], v[74:75], v[84:85]
    v_pk_mul_f32 v[78:79], v[78:79], v[86:87]
    v_cvt_pk_bf16_f32 v65, v66, v67
    v_cvt_pk_bf16_f32 v69, v70, v71
    v_cvt_pk_bf16_f32 v73, v74, v75
    v_cvt_pk_bf16_f32 v77, v78, v79
    v_mfma_f32_16x16x16_bf16 v[96:99], v[92:93], v[48:49], v[96:99]
    v_mfma_f32_16x16x16_bf16 v[100:103], v[92:93], v[52:53], v[100:103]
    v_mfma_f32_16x16x16_bf16 v[104:107], v[92:93], v[56:57], v[104:107]
    v_mfma_f32_16x16x16_bf16 v[108:111], v[92:93], v[60:61], v[108:111]
    v_mfma_f32_16x16x16_bf16 v[112:115], v[92:93], v[64:65], v[112:115]
    v_mfma_f32_16x16x16_bf16 v[116:119], v[92:93], v[68:69], v[116:119]
    v_mfma_f32_16x16x16_bf16 v[120:123], v[92:93], v[72:73], v[120:123]
    v_mfma_f32_16x16x16_bf16 v[124:127], v[92:93], v[76:77], v[124:127]
    s_mov_b32 s39, s42
    s_nop 6
    s_branch K2_TILE
K2_LAST:
    s_lshl_b32 s41, s39, 5
    v_add_u32 v92, s41, v3
    ds_read_b64 v[92:93], v92
    ds_read_b128 v[80:83], v8
    ds_read_b128 v[84:87], v8 offset:1024
    v_mov_b32 v10, 0x80000000
    v_lshrrev_b32 v94, 8, v8
    v_lshlrev_b32 v94, 2, v94
    s_lshl_b32 s28, s3, 2
    v_add_u32 v95, 0, v94
    v_add_u32 v12, s56, v95
    v_lshlrev_b32 v12, 8, v12
    v_add3_u32 v12, v12, v1, s28
    v_cmp_gt_u32 vcc, s57, v95
    s_nop 1
    v_cndmask_b32 v12, v10, v12, vcc
    v_add_u32 v95, 1, v94
    v_add_u32 v13, s56, v95
    v_lshlrev_b32 v13, 8, v13
    v_add3_u32 v13, v13, v1, s28
    v_cmp_gt_u32 vcc, s57, v95
    s_nop 1
    v_cndmask_b32 v13, v10, v13, vcc
    v_add_u32 v95, 2, v94
    v_add_u32 v14, s56, v95
    v_lshlrev_b32 v14, 8, v14
    v_add3_u32 v14, v14, v1, s28
    v_cmp_gt_u32 vcc, s57, v95
    s_nop 1
    v_cndmask_b32 v14, v10, v14, vcc
    v_add_u32 v95, 3, v94
    v_add_u32 v15, s56, v95
    v_lshlrev_b32 v15, 8, v15
    v_add3_u32 v15, v15, v1, s28
    v_cmp_gt_u32 vcc, s57, v95
    s_nop 1
    v_cndmask_b32 v15, v10, v15, vcc
    buffer_load_dword v12, v12, s[20:23], 0 offen
    buffer_load_dword v13, v13, s[20:23], 0 offen
    buffer_load_dword v14, v14, s[20:23], 0 offen
    buffer_load_dword v15, v15, s[20:23], 0 offen
    s_mov_b32 s59, 1
    s_waitcnt vmcnt(12)
    v_lshlrev_b32 v48, 16, v16
    v_and_b32 v52, 0xffff0000, v16
    v_lshlrev_b32 v56, 16, v17
    v_and_b32 v60, 0xffff0000, v17
    v_lshlrev_b32 v64, 16, v18
    v_and_b32 v68, 0xffff0000, v18
    v_lshlrev_b32 v72, 16, v19
    v_and_b32 v76, 0xffff0000, v19
    s_waitcnt vmcnt(11)
    v_lshlrev_b32 v49, 16, v20
    v_and_b32 v53, 0xffff0000, v20
    v_lshlrev_b32 v57, 16, v21
    v_and_b32 v61, 0xffff0000, v21
    v_lshlrev_b32 v65, 16, v22
    v_and_b32 v69, 0xffff0000, v22
    v_lshlrev_b32 v73, 16, v23
    v_and_b32 v77, 0xffff0000, v23
    s_waitcnt vmcnt(10)
    v_lshlrev_b32 v50, 16, v24
    v_and_b32 v54, 0xffff0000, v24
    v_lshlrev_b32 v58, 16, v25
    v_and_b32 v62, 0xffff0000, v25
    v_lshlrev_b32 v66, 16, v26
    v_and_b32 v70, 0xffff0000, v26
    v_lshlrev_b32 v74, 16, v27
    v_and_b32 v78, 0xffff0000, v27
    s_waitcnt vmcnt(9)
    v_lshlrev_b32 v51, 16, v28
    v_and_b32 v55, 0xffff0000, v28
    v_lshlrev_b32 v59, 16, v29
    v_and_b32 v63, 0xffff0000, v29
    v_lshlrev_b32 v67, 16, v30
    v_and_b32 v71, 0xffff0000, v30
    v_lshlrev_b32 v75, 16, v31
    v_and_b32 v79, 0xffff0000, v31
    s_waitcnt vmcnt(8)
    s_waitcnt lgkmcnt(1)
    v_mfma_f32_16x16x32_bf16 v[48:51], v[88:91], v[80:83], v[48:51]
    ds_read_b128 v[80:83], v8 offset:2048
    s_waitcnt lgkmcnt(1)
    v_mfma_f32_16x16x32_bf16 v[52:55], v[88:91], v[84:87], v[52:55]
    ds_read_b128 v[84:87], v8 offset:3072
    s_waitcnt lgkmcnt(1)
    v_mfma_f32_16x16x32_bf16 v[56:59], v[88:91], v[80:83], v[56:59]
    ds_read_b128 v[80:83], v8 offset:4096
    s_waitcnt lgkmcnt(1)
    v_mfma_f32_16x16x32_bf16 v[60:63], v[88:91], v[84:87], v[60:63]
    ds_read_b128 v[84:87], v8 offset:5120
    s_waitcnt lgkmcnt(1)
    v_mfma_f32_16x16x32_bf16 v[64:67], v[88:91], v[80:83], v[64:67]
    ds_read_b128 v[80:83], v8 offset:6144
    s_waitcnt lgkmcnt(1)
    v_mfma_f32_16x16x32_bf16 v[68:71], v[88:91], v[84:87], v[68:71]
    ds_read_b128 v[84:87], v8 offset:7168
    s_waitcnt lgkmcnt(1)
    v_mfma_f32_16x16x32_bf16 v[72:75], v[88:91], v[80:83], v[72:75]
    s_waitcnt lgkmcnt(0)
    v_mfma_f32_16x16x32_bf16 v[76:79], v[88:91], v[84:87], v[76:79]
    v_lshrrev_b32 v92, v5, v92
    v_and_b32 v92, 0x10001, v92
    v_mul_u32_u24 v92, 0x3f80, v92
    v_lshrrev_b32 v93, v5, v93
    v_and_b32 v93, 0x10001, v93
    v_mul_u32_u24 v93, 0x3f80, v93
    s_waitcnt vmcnt(6)
    v_exp_f32 v48, v48
    v_exp_f32 v49, v49
    v_exp_f32 v52, v52
    v_exp_f32 v53, v53
    v_exp_f32 v56, v56
    v_exp_f32 v57, v57
    v_exp_f32 v60, v60
    v_exp_f32 v61, v61
    v_pk_add_f32 v[48:49], v[48:49], s[66:67]
    v_pk_add_f32 v[52:53], v[52:53], s[66:67]
    v_pk_add_f32 v[56:57], v[56:57], s[66:67]
    v_pk_add_f32 v[60:61], v[60:61], s[66:67]
    v_rcp_f32 v48, v48
    v_rcp_f32 v49, v49
    v_rcp_f32 v52, v52
    v_rcp_f32 v53, v53
    v_rcp_f32 v56, v56
    v_rcp_f32 v57, v57
    v_rcp_f32 v60, v60
    v_rcp_f32 v61, v61
    v_lshlrev_b32 v80, 16, v32
    v_lshlrev_b32 v81, 16, v36
    v_and_b32 v82, 0xffff0000, v32
    v_and_b32 v83, 0xffff0000, v36
    v_lshlrev_b32 v84, 16, v33
    v_lshlrev_b32 v85, 16, v37
    v_and_b32 v86, 0xffff0000, v33
    v_and_b32 v87, 0xffff0000, v37
    v_pk_mul_f32 v[48:49], v[48:49], v[80:81]
    v_pk_mul_f32 v[52:53], v[52:53], v[82:83]
    v_pk_mul_f32 v[56:57], v[56:57], v[84:85]
    v_pk_mul_f32 v[60:61], v[60:61], v[86:87]
    v_cvt_pk_bf16_f32 v48, v48, v49
    v_cvt_pk_bf16_f32 v52, v52, v53
    v_cvt_pk_bf16_f32 v56, v56, v57
    v_cvt_pk_bf16_f32 v60, v60, v61
    v_exp_f32 v64, v64
    v_exp_f32 v65, v65
    v_exp_f32 v68, v68
    v_exp_f32 v69, v69
    v_exp_f32 v72, v72
    v_exp_f32 v73, v73
    v_exp_f32 v76, v76
    v_exp_f32 v77, v77
    v_pk_add_f32 v[64:65], v[64:65], s[66:67]
    v_pk_add_f32 v[68:69], v[68:69], s[66:67]
    v_pk_add_f32 v[72:73], v[72:73], s[66:67]
    v_pk_add_f32 v[76:77], v[76:77], s[66:67]
    v_rcp_f32 v64, v64
    v_rcp_f32 v65, v65
    v_rcp_f32 v68, v68
    v_rcp_f32 v69, v69
    v_rcp_f32 v72, v72
    v_rcp_f32 v73, v73
    v_rcp_f32 v76, v76
    v_rcp_f32 v77, v77
    v_lshlrev_b32 v80, 16, v34
    v_lshlrev_b32 v81, 16, v38
    v_and_b32 v82, 0xffff0000, v34
    v_and_b32 v83, 0xffff0000, v38
    v_lshlrev_b32 v84, 16, v35
    v_lshlrev_b32 v85, 16, v39
    v_and_b32 v86, 0xffff0000, v35
    v_and_b32 v87, 0xffff0000, v39
    v_pk_mul_f32 v[64:65], v[64:65], v[80:81]
    v_pk_mul_f32 v[68:69], v[68:69], v[82:83]
    v_pk_mul_f32 v[72:73], v[72:73], v[84:85]
    v_pk_mul_f32 v[76:77], v[76:77], v[86:87]
    v_cvt_pk_bf16_f32 v64, v64, v65
    v_cvt_pk_bf16_f32 v68, v68, v69
    v_cvt_pk_bf16_f32 v72, v72, v73
    v_cvt_pk_bf16_f32 v76, v76, v77
    s_waitcnt vmcnt(4)
    v_exp_f32 v50, v50
    v_exp_f32 v51, v51
    v_exp_f32 v54, v54
    v_exp_f32 v55, v55
    v_exp_f32 v58, v58
    v_exp_f32 v59, v59
    v_exp_f32 v62, v62
    v_exp_f32 v63, v63
    v_pk_add_f32 v[50:51], v[50:51], s[66:67]
    v_pk_add_f32 v[54:55], v[54:55], s[66:67]
    v_pk_add_f32 v[58:59], v[58:59], s[66:67]
    v_pk_add_f32 v[62:63], v[62:63], s[66:67]
    v_rcp_f32 v50, v50
    v_rcp_f32 v51, v51
    v_rcp_f32 v54, v54
    v_rcp_f32 v55, v55
    v_rcp_f32 v58, v58
    v_rcp_f32 v59, v59
    v_rcp_f32 v62, v62
    v_rcp_f32 v63, v63
    v_lshlrev_b32 v80, 16, v40
    v_lshlrev_b32 v81, 16, v44
    v_and_b32 v82, 0xffff0000, v40
    v_and_b32 v83, 0xffff0000, v44
    v_lshlrev_b32 v84, 16, v41
    v_lshlrev_b32 v85, 16, v45
    v_and_b32 v86, 0xffff0000, v41
    v_and_b32 v87, 0xffff0000, v45
    v_pk_mul_f32 v[50:51], v[50:51], v[80:81]
    v_pk_mul_f32 v[54:55], v[54:55], v[82:83]
    v_pk_mul_f32 v[58:59], v[58:59], v[84:85]
    v_pk_mul_f32 v[62:63], v[62:63], v[86:87]
    v_cvt_pk_bf16_f32 v49, v50, v51
    v_cvt_pk_bf16_f32 v53, v54, v55
    v_cvt_pk_bf16_f32 v57, v58, v59
    v_cvt_pk_bf16_f32 v61, v62, v63
    v_exp_f32 v66, v66
    v_exp_f32 v67, v67
    v_exp_f32 v70, v70
    v_exp_f32 v71, v71
    v_exp_f32 v74, v74
    v_exp_f32 v75, v75
    v_exp_f32 v78, v78
    v_exp_f32 v79, v79
    v_pk_add_f32 v[66:67], v[66:67], s[66:67]
    v_pk_add_f32 v[70:71], v[70:71], s[66:67]
    v_pk_add_f32 v[74:75], v[74:75], s[66:67]
    v_pk_add_f32 v[78:79], v[78:79], s[66:67]
    v_rcp_f32 v66, v66
    v_rcp_f32 v67, v67
    v_rcp_f32 v70, v70
    v_rcp_f32 v71, v71
    v_rcp_f32 v74, v74
    v_rcp_f32 v75, v75
    v_rcp_f32 v78, v78
    v_rcp_f32 v79, v79
    v_lshlrev_b32 v80, 16, v42
    v_lshlrev_b32 v81, 16, v46
    v_and_b32 v82, 0xffff0000, v42
    v_and_b32 v83, 0xffff0000, v46
    v_lshlrev_b32 v84, 16, v43
    v_lshlrev_b32 v85, 16, v47
    v_and_b32 v86, 0xffff0000, v43
    v_and_b32 v87, 0xffff0000, v47
    v_pk_mul_f32 v[66:67], v[66:67], v[80:81]
    v_pk_mul_f32 v[70:71], v[70:71], v[82:83]
    v_pk_mul_f32 v[74:75], v[74:75], v[84:85]
    v_pk_mul_f32 v[78:79], v[78:79], v[86:87]
    v_cvt_pk_bf16_f32 v65, v66, v67
    v_cvt_pk_bf16_f32 v69, v70, v71
    v_cvt_pk_bf16_f32 v73, v74, v75
    v_cvt_pk_bf16_f32 v77, v78, v79
    v_mfma_f32_16x16x16_bf16 v[96:99], v[92:93], v[48:49], v[96:99]
    v_mfma_f32_16x16x16_bf16 v[100:103], v[92:93], v[52:53], v[100:103]
    v_mfma_f32_16x16x16_bf16 v[104:107], v[92:93], v[56:57], v[104:107]
    v_mfma_f32_16x16x16_bf16 v[108:111], v[92:93], v[60:61], v[108:111]
    v_mfma_f32_16x16x16_bf16 v[112:115], v[92:93], v[64:65], v[112:115]
    v_mfma_f32_16x16x16_bf16 v[116:119], v[92:93], v[68:69], v[116:119]
    v_mfma_f32_16x16x16_bf16 v[120:123], v[92:93], v[72:73], v[120:123]
    v_mfma_f32_16x16x16_bf16 v[124:127], v[92:93], v[76:77], v[124:127]
    s_nop 7
K2_TILES_DONE:
    s_barrier
    s_or_b32 s26, s52, s33
    s_add_u32 s27, s54, 1792
    s_cmp_lt_u32 s27, s31
    s_cselect_b32 s27, 1, 0
    s_or_b32 s26, s26, s27
    s_cmp_lg_u32 s26, 0
    s_cbranch_scc1 K2_MORE
K2_RED:
    s_lshl_b32 s26, s3, 13
    v_add_u32 v28, s26, v8
    ds_write_b128 v28, v[96:99] offset:0
    ds_write_b128 v28, v[100:103] offset:1024
    ds_write_b128 v28, v[104:107] offset:2048
    ds_write_b128 v28, v[108:111] offset:3072
    ds_write_b128 v28, v[112:115] offset:4096
    ds_write_b128 v28, v[116:119] offset:5120
    ds_write_b128 v28, v[120:123] offset:6144
    ds_write_b128 v28, v[124:127] offset:7168
    s_mov_b32 s16, s10
    s_mov_b32 s17, s11
    s_mov_b32 s18, 0x30d400
    s_mov_b32 s19, 0x00020000
    v_mov_b32 v10, 0x80000000
    v_lshrrev_b32 v94, 8, v8
    v_lshlrev_b32 v94, 2, v94
    s_lshl_b32 s28, s3, 2
    v_add_u32 v95, 0, v94
    v_add_u32 v20, s56, v95
    v_lshlrev_b32 v20, 8, v20
    v_add3_u32 v20, v20, v1, s28
    v_cmp_gt_u32 vcc, s57, v95
    s_nop 1
    v_cndmask_b32 v20, v10, v20, vcc
    v_add_u32 v95, 1, v94
    v_add_u32 v21, s56, v95
    v_lshlrev_b32 v21, 8, v21
    v_add3_u32 v21, v21, v1, s28
    v_cmp_gt_u32 vcc, s57, v95
    s_nop 1
    v_cndmask_b32 v21, v10, v21, vcc
    v_add_u32 v95, 2, v94
    v_add_u32 v22, s56, v95
    v_lshlrev_b32 v22, 8, v22
    v_add3_u32 v22, v22, v1, s28
    v_cmp_gt_u32 vcc, s57, v95
    s_nop 1
    v_cndmask_b32 v22, v10, v22, vcc
    v_add_u32 v95, 3, v94
    v_add_u32 v23, s56, v95
    v_lshlrev_b32 v23, 8, v23
    v_add3_u32 v23, v23, v1, s28
    v_cmp_gt_u32 vcc, s57, v95
    s_nop 1
    v_cndmask_b32 v23, v10, v23, vcc
    s_cmp_lg_u32 s59, 0
    s_nop 0
    s_cbranch_scc1 K2_XUOK
    buffer_load_dword v12, v20, s[20:23], 0 offen
    buffer_load_dword v13, v21, s[20:23], 0 offen
    buffer_load_dword v14, v22, s[20:23], 0 offen
    buffer_load_dword v15, v23, s[20:23], 0 offen
K2_XUOK:
    s_waitcnt lgkmcnt(0)
    s_barrier
    s_lshl_b32 s26, s3, 11
    v_add_u32 v28, s26, v8
    ds_read_b128 v[96:99], v28 offset:0
    ds_read_b128 v[100:103], v28 offset:8192
    ds_read_b128 v[104:107], v28 offset:16384
    ds_read_b128 v[108:111], v28 offset:24576
    ds_read_b128 v[112:115], v28 offset:1024
    ds_read_b128 v[116:119], v28 offset:9216
    ds_read_b128 v[120:123], v28 offset:17408
    ds_read_b128 v[124:127], v28 offset:25600
    s_waitcnt lgkmcnt(0)
    v_add_f32 v96, v96, v100
    v_add_f32 v104, v104, v108
    v_add_f32 v80, v96, v104
    v_add_f32 v97, v97, v101
    v_add_f32 v105, v105, v109
    v_add_f32 v81, v97, v105
    v_add_f32 v98, v98, v102
    v_add_f32 v106, v106, v110
    v_add_f32 v82, v98, v106
    v_add_f32 v99, v99, v103
    v_add_f32 v107, v107, v111
    v_add_f32 v83, v99, v107
    v_add_f32 v112, v112, v116
    v_add_f32 v120, v120, v124
    v_add_f32 v84, v112, v120
    v_add_f32 v113, v113, v117
    v_add_f32 v121, v121, v125
    v_add_f32 v85, v113, v121
    v_add_f32 v114, v114, v118
    v_add_f32 v122, v122, v126
    v_add_f32 v86, v114, v122
    v_add_f32 v115, v115, v119
    v_add_f32 v123, v123, v127
    v_add_f32 v87, v115, v123
    s_waitcnt vmcnt(0)
    v_lshlrev_b32 v64, 16, v12
    v_and_b32 v65, 0xffff0000, v12
    v_add_f32 v64, v64, v80
    v_add_f32 v65, v65, v84
    v_mul_f32 v66, 0xbfb8aa3b, v64
    v_mul_f32 v67, 0xbfb8aa3b, v65
    v_exp_f32 v66, v66
    v_exp_f32 v67, v67
    v_add_f32 v66, 1.0, v66
    v_add_f32 v67, 1.0, v67
    v_rcp_f32 v66, v66
    v_rcp_f32 v67, v67
    v_mul_f32 v64, v64, v66
    v_mul_f32 v65, v65, v67
    v_cvt_pk_bf16_f32 v68, v64, v65
    buffer_store_dword v68, v20, s[16:19], 0 offen
    v_lshlrev_b32 v64, 16, v13
    v_and_b32 v65, 0xffff0000, v13
    v_add_f32 v64, v64, v81
    v_add_f32 v65, v65, v85
    v_mul_f32 v66, 0xbfb8aa3b, v64
    v_mul_f32 v67, 0xbfb8aa3b, v65
    v_exp_f32 v66, v66
    v_exp_f32 v67, v67
    v_add_f32 v66, 1.0, v66
    v_add_f32 v67, 1.0, v67
    v_rcp_f32 v66, v66
    v_rcp_f32 v67, v67
    v_mul_f32 v64, v64, v66
    v_mul_f32 v65, v65, v67
    v_cvt_pk_bf16_f32 v69, v64, v65
    buffer_store_dword v69, v21, s[16:19], 0 offen
    v_lshlrev_b32 v64, 16, v14
    v_and_b32 v65, 0xffff0000, v14
    v_add_f32 v64, v64, v82
    v_add_f32 v65, v65, v86
    v_mul_f32 v66, 0xbfb8aa3b, v64
    v_mul_f32 v67, 0xbfb8aa3b, v65
    v_exp_f32 v66, v66
    v_exp_f32 v67, v67
    v_add_f32 v66, 1.0, v66
    v_add_f32 v67, 1.0, v67
    v_rcp_f32 v66, v66
    v_rcp_f32 v67, v67
    v_mul_f32 v64, v64, v66
    v_mul_f32 v65, v65, v67
    v_cvt_pk_bf16_f32 v70, v64, v65
    buffer_store_dword v70, v22, s[16:19], 0 offen
    v_lshlrev_b32 v64, 16, v15
    v_and_b32 v65, 0xffff0000, v15
    v_add_f32 v64, v64, v83
    v_add_f32 v65, v65, v87
    v_mul_f32 v66, 0xbfb8aa3b, v64
    v_mul_f32 v67, 0xbfb8aa3b, v65
    v_exp_f32 v66, v66
    v_exp_f32 v67, v67
    v_add_f32 v66, 1.0, v66
    v_add_f32 v67, 1.0, v67
    v_rcp_f32 v66, v66
    v_rcp_f32 v67, v67
    v_mul_f32 v64, v64, v66
    v_mul_f32 v65, v65, v67
    v_cvt_pk_bf16_f32 v71, v64, v65
    buffer_store_dword v71, v23, s[16:19], 0 offen
    s_nop 0
K2_END:
    s_endpgm
K2_COUNT_X:
    v_cmp_lt_u32 vcc, 7, v16
    s_and_b64 exec, exec, vcc
    s_nop 3
    s_cbranch_execz K2_COUNTED
    v_lshrrev_b32 v14, 8, v24
    v_and_b32 v14, 48, v14
    v_lshlrev_b64 v[34:35], v14, v[36:37]
    v_add_u32 v32, v32, v34
    v_add_u32 v33, v33, v35
    v_cmp_lt_u32 vcc, 8, v16
    s_and_b64 exec, exec, vcc
    s_nop 3
    s_cbranch_execz K2_COUNTED
    v_lshrrev_b32 v14, 8, v25
    v_and_b32 v14, 48, v14
    v_lshlrev_b64 v[34:35], v14, v[36:37]
    v_add_u32 v32, v32, v34
    v_add_u32 v33, v33, v35
    v_cmp_lt_u32 vcc, 9, v16
    s_and_b64 exec, exec, vcc
    s_nop 3
    s_cbranch_execz K2_COUNTED
    v_lshrrev_b32 v14, 8, v26
    v_and_b32 v14, 48, v14
    v_lshlrev_b64 v[34:35], v14, v[36:37]
    v_add_u32 v32, v32, v34
    v_add_u32 v33, v33, v35
    v_cmp_lt_u32 vcc, 10, v16
    s_and_b64 exec, exec, vcc
    s_nop 3
    s_cbranch_execz K2_COUNTED
    v_lshrrev_b32 v14, 8, v27
    v_and_b32 v14, 48, v14
    v_lshlrev_b64 v[34:35], v14, v[36:37]
    v_add_u32 v32, v32, v34
    v_add_u32 v33, v33, v35
    v_cmp_lt_u32 vcc, 11, v16
    s_and_b64 exec, exec, vcc
    s_nop 3
    s_cbranch_execz K2_COUNTED
    v_lshrrev_b32 v14, 8, v28
    v_and_b32 v14, 48, v14
    v_lshlrev_b64 v[34:35], v14, v[36:37]
    v_add_u32 v32, v32, v34
    v_add_u32 v33, v33, v35
    v_cmp_lt_u32 vcc, 12, v16
    s_and_b64 exec, exec, vcc
    s_nop 3
    s_cbranch_execz K2_COUNTED
    v_lshrrev_b32 v14, 8, v29
    v_and_b32 v14, 48, v14
    v_lshlrev_b64 v[34:35], v14, v[36:37]
    v_add_u32 v32, v32, v34
    v_add_u32 v33, v33, v35
    v_cmp_lt_u32 vcc, 13, v16
    s_and_b64 exec, exec, vcc
    s_nop 3
    s_cbranch_execz K2_COUNTED
    v_lshrrev_b32 v14, 8, v30
    v_and_b32 v14, 48, v14
    v_lshlrev_b64 v[34:35], v14, v[36:37]
    v_add_u32 v32, v32, v34
    v_add_u32 v33, v33, v35
    v_cmp_lt_u32 vcc, 14, v16
    s_and_b64 exec, exec, vcc
    s_nop 3
    s_cbranch_execz K2_COUNTED
    v_lshrrev_b32 v14, 8, v31
    v_and_b32 v14, 48, v14
    v_lshlrev_b64 v[34:35], v14, v[36:37]
    v_add_u32 v32, v32, v34
    v_add_u32 v33, v33, v35
    s_nop 1
    s_branch K2_COUNTED
K2_FILL_X:
    v_cmp_lt_u32 vcc, 7, v16
    s_and_b64 exec, exec, vcc
    s_nop 3
    s_cbranch_execz K2_FILLED
    v_lshrrev_b32 v14, 8, v24
    v_and_b32 v14, 48, v14
    v_lshrrev_b64 v[34:35], v14, v[32:33]
    v_and_b32 v34, 0xffff, v34
    v_subrev_u32 v34, s54, v34
    v_lshlrev_b64 v[38:39], v14, v[36:37]
    v_add_u32 v32, v32, v38
    v_add_u32 v33, v33, v39
    v_cmp_gt_u32 vcc, s32, v34
    s_and_saveexec_b64 s[26:27], vcc
    v_and_b32 v40, 0x3fff, v24
    v_lshlrev_b32 v40, 9, v40
    v_bfe_u32 v41, v24, 14, 4
    v_lshrrev_b32 v42, 18, v24
    v_add_lshl_u32 v42, v42, v0, 5
    v_lshlrev_b32 v43, 2, v34
    ds_write_b32 v43, v40 offset:8192
    ds_write_b32 v43, v42 offset:15424
    v_lshlrev_b32 v44, 5, v41
    ds_write_b32 v43, v44 offset:22656
    v_lshlrev_b32 v41, v41, v11
    v_lshlrev_b32 v43, 1, v34
    ds_write_b16 v43, v41 offset:29888
    s_mov_b64 exec, s[26:27]
    v_cmp_lt_u32 vcc, 8, v16
    s_and_b64 exec, exec, vcc
    s_nop 3
    s_cbranch_execz K2_FILLED
    v_lshrrev_b32 v14, 8, v25
    v_and_b32 v14, 48, v14
    v_lshrrev_b64 v[34:35], v14, v[32:33]
    v_and_b32 v34, 0xffff, v34
    v_subrev_u32 v34, s54, v34
    v_lshlrev_b64 v[38:39], v14, v[36:37]
    v_add_u32 v32, v32, v38
    v_add_u32 v33, v33, v39
    v_cmp_gt_u32 vcc, s32, v34
    s_and_saveexec_b64 s[26:27], vcc
    v_and_b32 v40, 0x3fff, v25
    v_lshlrev_b32 v40, 9, v40
    v_bfe_u32 v41, v25, 14, 4
    v_lshrrev_b32 v42, 18, v25
    v_add_lshl_u32 v42, v42, v0, 5
    v_lshlrev_b32 v43, 2, v34
    ds_write_b32 v43, v40 offset:8192
    ds_write_b32 v43, v42 offset:15424
    v_lshlrev_b32 v44, 5, v41
    ds_write_b32 v43, v44 offset:22656
    v_lshlrev_b32 v41, v41, v11
    v_lshlrev_b32 v43, 1, v34
    ds_write_b16 v43, v41 offset:29888
    s_mov_b64 exec, s[26:27]
    v_cmp_lt_u32 vcc, 9, v16
    s_and_b64 exec, exec, vcc
    s_nop 3
    s_cbranch_execz K2_FILLED
    v_lshrrev_b32 v14, 8, v26
    v_and_b32 v14, 48, v14
    v_lshrrev_b64 v[34:35], v14, v[32:33]
    v_and_b32 v34, 0xffff, v34
    v_subrev_u32 v34, s54, v34
    v_lshlrev_b64 v[38:39], v14, v[36:37]
    v_add_u32 v32, v32, v38
    v_add_u32 v33, v33, v39
    v_cmp_gt_u32 vcc, s32, v34
    s_and_saveexec_b64 s[26:27], vcc
    v_and_b32 v40, 0x3fff, v26
    v_lshlrev_b32 v40, 9, v40
    v_bfe_u32 v41, v26, 14, 4
    v_lshrrev_b32 v42, 18, v26
    v_add_lshl_u32 v42, v42, v0, 5
    v_lshlrev_b32 v43, 2, v34
    ds_write_b32 v43, v40 offset:8192
    ds_write_b32 v43, v42 offset:15424
    v_lshlrev_b32 v44, 5, v41
    ds_write_b32 v43, v44 offset:22656
    v_lshlrev_b32 v41, v41, v11
    v_lshlrev_b32 v43, 1, v34
    ds_write_b16 v43, v41 offset:29888
    s_mov_b64 exec, s[26:27]
    v_cmp_lt_u32 vcc, 10, v16
    s_and_b64 exec, exec, vcc
    s_nop 3
    s_cbranch_execz K2_FILLED
    v_lshrrev_b32 v14, 8, v27
    v_and_b32 v14, 48, v14
    v_lshrrev_b64 v[34:35], v14, v[32:33]
    v_and_b32 v34, 0xffff, v34
    v_subrev_u32 v34, s54, v34
    v_lshlrev_b64 v[38:39], v14, v[36:37]
    v_add_u32 v32, v32, v38
    v_add_u32 v33, v33, v39
    v_cmp_gt_u32 vcc, s32, v34
    s_and_saveexec_b64 s[26:27], vcc
    v_and_b32 v40, 0x3fff, v27
    v_lshlrev_b32 v40, 9, v40
    v_bfe_u32 v41, v27, 14, 4
    v_lshrrev_b32 v42, 18, v27
    v_add_lshl_u32 v42, v42, v0, 5
    v_lshlrev_b32 v43, 2, v34
    ds_write_b32 v43, v40 offset:8192
    ds_write_b32 v43, v42 offset:15424
    v_lshlrev_b32 v44, 5, v41
    ds_write_b32 v43, v44 offset:22656
    v_lshlrev_b32 v41, v41, v11
    v_lshlrev_b32 v43, 1, v34
    ds_write_b16 v43, v41 offset:29888
    s_mov_b64 exec, s[26:27]
    v_cmp_lt_u32 vcc, 11, v16
    s_and_b64 exec, exec, vcc
    s_nop 3
    s_cbranch_execz K2_FILLED
    v_lshrrev_b32 v14, 8, v28
    v_and_b32 v14, 48, v14
    v_lshrrev_b64 v[34:35], v14, v[32:33]
    v_and_b32 v34, 0xffff, v34
    v_subrev_u32 v34, s54, v34
    v_lshlrev_b64 v[38:39], v14, v[36:37]
    v_add_u32 v32, v32, v38
    v_add_u32 v33, v33, v39
    v_cmp_gt_u32 vcc, s32, v34
    s_and_saveexec_b64 s[26:27], vcc
    v_and_b32 v40, 0x3fff, v28
    v_lshlrev_b32 v40, 9, v40
    v_bfe_u32 v41, v28, 14, 4
    v_lshrrev_b32 v42, 18, v28
    v_add_lshl_u32 v42, v42, v0, 5
    v_lshlrev_b32 v43, 2, v34
    ds_write_b32 v43, v40 offset:8192
    ds_write_b32 v43, v42 offset:15424
    v_lshlrev_b32 v44, 5, v41
    ds_write_b32 v43, v44 offset:22656
    v_lshlrev_b32 v41, v41, v11
    v_lshlrev_b32 v43, 1, v34
    ds_write_b16 v43, v41 offset:29888
    s_mov_b64 exec, s[26:27]
    v_cmp_lt_u32 vcc, 12, v16
    s_and_b64 exec, exec, vcc
    s_nop 3
    s_cbranch_execz K2_FILLED
    v_lshrrev_b32 v14, 8, v29
    v_and_b32 v14, 48, v14
    v_lshrrev_b64 v[34:35], v14, v[32:33]
    v_and_b32 v34, 0xffff, v34
    v_subrev_u32 v34, s54, v34
    v_lshlrev_b64 v[38:39], v14, v[36:37]
    v_add_u32 v32, v32, v38
    v_add_u32 v33, v33, v39
    v_cmp_gt_u32 vcc, s32, v34
    s_and_saveexec_b64 s[26:27], vcc
    v_and_b32 v40, 0x3fff, v29
    v_lshlrev_b32 v40, 9, v40
    v_bfe_u32 v41, v29, 14, 4
    v_lshrrev_b32 v42, 18, v29
    v_add_lshl_u32 v42, v42, v0, 5
    v_lshlrev_b32 v43, 2, v34
    ds_write_b32 v43, v40 offset:8192
    ds_write_b32 v43, v42 offset:15424
    v_lshlrev_b32 v44, 5, v41
    ds_write_b32 v43, v44 offset:22656
    v_lshlrev_b32 v41, v41, v11
    v_lshlrev_b32 v43, 1, v34
    ds_write_b16 v43, v41 offset:29888
    s_mov_b64 exec, s[26:27]
    v_cmp_lt_u32 vcc, 13, v16
    s_and_b64 exec, exec, vcc
    s_nop 3
    s_cbranch_execz K2_FILLED
    v_lshrrev_b32 v14, 8, v30
    v_and_b32 v14, 48, v14
    v_lshrrev_b64 v[34:35], v14, v[32:33]
    v_and_b32 v34, 0xffff, v34
    v_subrev_u32 v34, s54, v34
    v_lshlrev_b64 v[38:39], v14, v[36:37]
    v_add_u32 v32, v32, v38
    v_add_u32 v33, v33, v39
    v_cmp_gt_u32 vcc, s32, v34
    s_and_saveexec_b64 s[26:27], vcc
    v_and_b32 v40, 0x3fff, v30
    v_lshlrev_b32 v40, 9, v40
    v_bfe_u32 v41, v30, 14, 4
    v_lshrrev_b32 v42, 18, v30
    v_add_lshl_u32 v42, v42, v0, 5
    v_lshlrev_b32 v43, 2, v34
    ds_write_b32 v43, v40 offset:8192
    ds_write_b32 v43, v42 offset:15424
    v_lshlrev_b32 v44, 5, v41
    ds_write_b32 v43, v44 offset:22656
    v_lshlrev_b32 v41, v41, v11
    v_lshlrev_b32 v43, 1, v34
    ds_write_b16 v43, v41 offset:29888
    s_mov_b64 exec, s[26:27]
    v_cmp_lt_u32 vcc, 14, v16
    s_and_b64 exec, exec, vcc
    s_nop 3
    s_cbranch_execz K2_FILLED
    v_lshrrev_b32 v14, 8, v31
    v_and_b32 v14, 48, v14
    v_lshrrev_b64 v[34:35], v14, v[32:33]
    v_and_b32 v34, 0xffff, v34
    v_subrev_u32 v34, s54, v34
    v_lshlrev_b64 v[38:39], v14, v[36:37]
    v_add_u32 v32, v32, v38
    v_add_u32 v33, v33, v39
    v_cmp_gt_u32 vcc, s32, v34
    s_and_saveexec_b64 s[26:27], vcc
    v_and_b32 v40, 0x3fff, v31
    v_lshlrev_b32 v40, 9, v40
    v_bfe_u32 v41, v31, 14, 4
    v_lshrrev_b32 v42, 18, v31
    v_add_lshl_u32 v42, v42, v0, 5
    v_lshlrev_b32 v43, 2, v34
    ds_write_b32 v43, v40 offset:8192
    ds_write_b32 v43, v42 offset:15424
    v_lshlrev_b32 v44, 5, v41
    ds_write_b32 v43, v44 offset:22656
    v_lshlrev_b32 v41, v41, v11
    v_lshlrev_b32 v43, 1, v34
    ds_write_b16 v43, v41 offset:29888
    s_mov_b64 exec, s[26:27]
    s_branch K2_FILLED
K2_MORE:
    s_mov_b32 s59, 0
    s_waitcnt vmcnt(0)
    s_cmp_lg_u32 s52, 0
    s_cbranch_scc1 K2_OVNEXT
    s_add_u32 s54, s54, 1792
    s_cmp_lt_u32 s54, s31
    s_cbranch_scc1 K2_FILL
    s_cmp_eq_u32 s33, 0
    s_cbranch_scc1 K2_RED
    v_lshlrev_b32 v12, 2, v9
    s_mov_b32 s24, 0x692000
    buffer_load_dword v92, v12, s[12:15], s24 offen
    s_waitcnt vmcnt(0)
    v_min_u32 v92, 1563, v92
    v_mov_b32 v80, v92
    s_nop 1
    v_max_u32_dpp v80, v80, v80 row_shr:1 row_mask:0xf bank_mask:0xf bound_ctrl:0
    s_nop 1
    v_max_u32_dpp v80, v80, v80 row_shr:2 row_mask:0xf bank_mask:0xf bound_ctrl:0
    s_nop 1
    v_max_u32_dpp v80, v80, v80 row_shr:4 row_mask:0xf bank_mask:0xf bound_ctrl:0
    s_nop 1
    v_max_u32_dpp v80, v80, v80 row_shr:8 row_mask:0xf bank_mask:0xf bound_ctrl:0
    s_nop 1
    v_max_u32_dpp v80, v80, v80 row_bcast:15 row_mask:0xa bank_mask:0xf
    s_nop 1
    v_max_u32_dpp v80, v80, v80 row_bcast:31 row_mask:0xc bank_mask:0xf
    s_nop 0
    v_readlane_b32 s28, v80, 63
    s_lshl_b32 s30, s3, 2
    s_nop 0
    v_mov_b32 v80, s28
    v_mov_b32 v82, s30
    ds_write_b32 v82, v80 offset:33552
    s_waitcnt lgkmcnt(0)
    s_barrier
    v_mov_b32 v82, 0
    ds_read_b128 v[84:87], v82 offset:33552
    s_waitcnt lgkmcnt(0)
    v_max3_u32 v84, v84, v85, v86
    v_max_u32 v84, v84, v87
    s_nop 0
    v_readfirstlane_b32 s53, v84
    s_nop 4
K2_OVNEXT:
    s_cmp_ge_u32 s52, s53
    s_cbranch_scc1 K2_RED0
    v_lshlrev_b32 v12, 2, v9
    s_mov_b32 s24, 0x692000
    buffer_load_dword v92, v12, s[12:15], s24 offen
    v_mul_u32_u24 v12, 12544, v9
    s_lshl_b32 s24, s52, 3
    s_add_u32 s24, s24, 0x6a0000
    buffer_load_dwordx4 v[16:19], v12, s[12:15], s24 offen
    buffer_load_dwordx4 v[20:23], v12, s[12:15], s24 offen offset:16
    s_waitcnt vmcnt(0)
    v_min_u32 v92, 1563, v92
    v_mov_b32 v32, 0
    v_mov_b32 v33, 0
    s_add_u32 s24, s52, 0
    v_cmp_lt_u32 vcc, s24, v92
    v_cmp_eq_u32 s[26:27], s55, v16
    s_and_b64 vcc, vcc, s[26:27]
    v_cndmask_b32 v24, 0, v11, vcc
    v_add_u32 v32, v32, v24
    s_add_u32 s24, s52, 1
    v_cmp_lt_u32 vcc, s24, v92
    v_cmp_eq_u32 s[26:27], s55, v18
    s_and_b64 vcc, vcc, s[26:27]
    v_cndmask_b32 v25, 0, v11, vcc
    v_add_u32 v32, v32, v25
    s_add_u32 s24, s52, 2
    v_cmp_lt_u32 vcc, s24, v92
    v_cmp_eq_u32 s[26:27], s55, v20
    s_and_b64 vcc, vcc, s[26:27]
    v_cndmask_b32 v26, 0, v11, vcc
    v_add_u32 v32, v32, v26
    s_add_u32 s24, s52, 3
    v_cmp_lt_u32 vcc, s24, v92
    v_cmp_eq_u32 s[26:27], s55, v22
    s_and_b64 vcc, vcc, s[26:27]
    v_cndmask_b32 v27, 0, v11, vcc
    v_add_u32 v32, v32, v27
    v_mov_b32 v80, v32
    v_mov_b32 v81, v33
    s_nop 0
    v_add_u32_dpp v80, v80, v80 row_shr:1 row_mask:0xf bank_mask:0xf bound_ctrl:0
    v_add_u32_dpp v81, v81, v81 row_shr:1 row_mask:0xf bank_mask:0xf bound_ctrl:0
    s_nop 0
    v_add_u32_dpp v80, v80, v80 row_shr:2 row_mask:0xf bank_mask:0xf bound_ctrl:0
    v_add_u32_dpp v81, v81, v81 row_shr:2 row_mask:0xf bank_mask:0xf bound_ctrl:0
    s_nop 0
    v_add_u32_dpp v80, v80, v80 row_shr:4 row_mask:0xf bank_mask:0xf bound_ctrl:0
    v_add_u32_dpp v81, v81, v81 row_shr:4 row_mask:0xf bank_mask:0xf bound_ctrl:0
    s_nop 0
    v_add_u32_dpp v80, v80, v80 row_shr:8 row_mask:0xf bank_mask:0xf bound_ctrl:0
    v_add_u32_dpp v81, v81, v81 row_shr:8 row_mask:0xf bank_mask:0xf bound_ctrl:0
    s_nop 0
    v_add_u32_dpp v80, v80, v80 row_bcast:15 row_mask:0xa bank_mask:0xf
    v_add_u32_dpp v81, v81, v81 row_bcast:15 row_mask:0xa bank_mask:0xf
    s_nop 0
    v_add_u32_dpp v80, v80, v80 row_bcast:31 row_mask:0xc bank_mask:0xf
    v_add_u32_dpp v81, v81, v81 row_bcast:31 row_mask:0xc bank_mask:0xf
    v_readlane_b32 s28, v80, 63
    v_readlane_b32 s29, v81, 63
    v_sub_u32 v32, v80, v32
    v_sub_u32 v33, v81, v33
    s_lshl_b32 s30, s3, 3
    v_mov_b32 v80, s28
    v_mov_b32 v81, s29
    v_mov_b32 v82, s30
    ds_write_b64 v82, v[80:81] offset:33504
    s_waitcnt lgkmcnt(0)
    s_barrier
    v_mov_b32 v82, 0
    ds_read_b128 v[84:87], v82 offset:33504
    ds_read_b128 v[88:91], v82 offset:33520
    s_waitcnt lgkmcnt(0)
    v_readfirstlane_b32 s44, v84
    v_readfirstlane_b32 s45, v85
    v_readfirstlane_b32 s46, v86
    v_readfirstlane_b32 s47, v87
    v_readfirstlane_b32 s48, v88
    v_readfirstlane_b32 s49, v89
    v_readfirstlane_b32 s50, v90
    v_readfirstlane_b32 s51, v91
    s_add_u32 s40, s44, s46
    s_add_u32 s40, s40, s48
    s_add_u32 s40, s40, s50
    s_add_u32 s41, s45, s47
    s_add_u32 s41, s41, s49
    s_add_u32 s41, s41, s51
    s_cmp_gt_u32 s3, 0
    s_cselect_b32 s44, s44, 0
    s_cselect_b32 s45, s45, 0
    s_cmp_gt_u32 s3, 1
    s_cselect_b32 s46, s46, 0
    s_cselect_b32 s47, s47, 0
    s_cmp_gt_u32 s3, 2
    s_cselect_b32 s48, s48, 0
    s_cselect_b32 s49, s49, 0
    s_add_u32 s44, s44, s46
    s_add_u32 s44, s44, s48
    s_add_u32 s45, s45, s47
    s_add_u32 s45, s45, s49
    s_mov_b32 s32, s40
    v_add_u32 v32, s44, v32
    s_mov_b64 s[36:37], exec
    s_mov_b64 exec, s[36:37]
    v_cmp_eq_u32 vcc, 1, v24
    s_and_b64 exec, s[36:37], vcc
    s_nop 3
    s_cbranch_execz K2_OVS0
    v_and_b32 v40, 0x3fff, v17
    v_lshlrev_b32 v40, 9, v40
    v_bfe_u32 v41, v17, 14, 4
    v_lshrrev_b32 v42, 18, v17
    v_add_lshl_u32 v42, v42, v0, 5
    v_lshlrev_b32 v43, 2, v32
    ds_write_b32 v43, v40 offset:8192
    ds_write_b32 v43, v42 offset:15424
    v_lshlrev_b32 v44, 5, v41
    ds_write_b32 v43, v44 offset:22656
    v_lshlrev_b32 v41, v41, v11
    v_lshlrev_b32 v43, 1, v32
    ds_write_b16 v43, v41 offset:29888
    v_add_u32 v32, 1, v32
    s_nop 1
K2_OVS0:
    s_mov_b64 exec, s[36:37]
    v_cmp_eq_u32 vcc, 1, v25
    s_and_b64 exec, s[36:37], vcc
    s_nop 3
    s_cbranch_execz K2_OVS1
    v_and_b32 v40, 0x3fff, v19
    v_lshlrev_b32 v40, 9, v40
    v_bfe_u32 v41, v19, 14, 4
    v_lshrrev_b32 v42, 18, v19
    v_add_lshl_u32 v42, v42, v0, 5
    v_lshlrev_b32 v43, 2, v32
    ds_write_b32 v43, v40 offset:8192
    ds_write_b32 v43, v42 offset:15424
    v_lshlrev_b32 v44, 5, v41
    ds_write_b32 v43, v44 offset:22656
    v_lshlrev_b32 v41, v41, v11
    v_lshlrev_b32 v43, 1, v32
    ds_write_b16 v43, v41 offset:29888
    v_add_u32 v32, 1, v32
    s_nop 1
K2_OVS1:
    s_mov_b64 exec, s[36:37]
    v_cmp_eq_u32 vcc, 1, v26
    s_and_b64 exec, s[36:37], vcc
    s_nop 3
    s_cbranch_execz K2_OVS2
    v_and_b32 v40, 0x3fff, v21
    v_lshlrev_b32 v40, 9, v40
    v_bfe_u32 v41, v21, 14, 4
    v_lshrrev_b32 v42, 18, v21
    v_add_lshl_u32 v42, v42, v0, 5
    v_lshlrev_b32 v43, 2, v32
    ds_write_b32 v43, v40 offset:8192
    ds_write_b32 v43, v42 offset:15424
    v_lshlrev_b32 v44, 5, v41
    ds_write_b32 v43, v44 offset:22656
    v_lshlrev_b32 v41, v41, v11
    v_lshlrev_b32 v43, 1, v32
    ds_write_b16 v43, v41 offset:29888
    v_add_u32 v32, 1, v32
    s_nop 1
K2_OVS2:
    s_mov_b64 exec, s[36:37]
    v_cmp_eq_u32 vcc, 1, v27
    s_and_b64 exec, s[36:37], vcc
    s_nop 3
    s_cbranch_execz K2_OVS3
    v_and_b32 v40, 0x3fff, v23
    v_lshlrev_b32 v40, 9, v40
    v_bfe_u32 v41, v23, 14, 4
    v_lshrrev_b32 v42, 18, v23
    v_add_lshl_u32 v42, v42, v0, 5
    v_lshlrev_b32 v43, 2, v32
    ds_write_b32 v43, v40 offset:8192
    ds_write_b32 v43, v42 offset:15424
    v_lshlrev_b32 v44, 5, v41
    ds_write_b32 v43, v44 offset:22656
    v_lshlrev_b32 v41, v41, v11
    v_lshlrev_b32 v43, 1, v32
    ds_write_b16 v43, v41 offset:29888
    v_add_u32 v32, 1, v32
    s_nop 1
K2_OVS3:
    s_mov_b64 exec, s[36:37]
    s_add_u32 s52, s52, 4
    s_branch K2_PROC
K2_RED0:
    s_branch K2_RED
.section .rodata,"a"
.p2align 6
.amdhsa_kernel egc_prep_kernel
  .amdhsa_next_free_vgpr 128
  .amdhsa_next_free_sgpr 64
  .amdhsa_accum_offset 128
  .amdhsa_group_segment_fixed_size 0
  .amdhsa_kernarg_size 80
  .amdhsa_user_sgpr_count 2
  .amdhsa_user_sgpr_kernarg_segment_ptr 1
  .amdhsa_system_sgpr_workgroup_id_x 1
.end_amdhsa_kernel
.p2align 6
.amdhsa_kernel standalone__edge_featured_mpnn_egc__graph_kernel
  .amdhsa_next_free_vgpr 128
  .amdhsa_next_free_sgpr 72
  .amdhsa_accum_offset 128
  .amdhsa_group_segment_fixed_size 0
  .amdhsa_kernarg_size 80
  .amdhsa_user_sgpr_count 2
  .amdhsa_user_sgpr_kernarg_segment_ptr 1
  .amdhsa_system_sgpr_workgroup_id_x 1
.end_amdhsa_kernel
```
